```python
import torch

def _softmax(x, axis=-1):
    return torch.softmax(x, dim=axis)
def _gelu(x):
    return torch.nn.functional.gelu(x, approximate="tanh")
def _silu(x):
    return torch.nn.functional.silu(x)
def _sigmoid(x):
    return torch.sigmoid(x)
def _layernorm(x, axis=-1, eps=1e-5):
    m = x.mean(dim=axis, keepdim=True)
    v = x.var(dim=axis, keepdim=True, unbiased=False)
    return (x - m) / torch.sqrt(v + eps)
def _scatter_add(tgt, idx, src, axis=0):
    return tgt.clone().index_add_(axis, idx, src)
def _segment_sum(src, seg, n):
    out = torch.zeros((n,) + src.shape[1:], dtype=src.dtype)
    return out.index_add_(0, seg, src)
def _pad(x, pw):
    flat = tuple(v for pair in reversed(pw) for v in pair)
    return torch.nn.functional.pad(x, flat)

kernel_name = 'gated_mix__sliding_block_cached__swiglu_ffn__decode'

def setup_inputs():

    _w = (lambda a: (lambda t: t.to(torch.bfloat16) if t.is_floating_point() else t)(torch.as_tensor(a)))
    def _A_setup():
        B, Sq, D = 8, 1, 576
        Hq, Hkv, Sk, Dh = 32, 16, 4096, 128
        assert Hq % Hkv == 0, (Hq, Hkv)
        return {
            "x": _w((lambda *s: torch.randn(*s, dtype=torch.bfloat16) * 0.05)(B, Sq, D)),
            "k_cache": _w((lambda *s: torch.randn(*s, dtype=torch.bfloat16) * 3.2)(B, Hkv, Sk, Dh)),
            "v_cache": _w((lambda *s: torch.randn(*s, dtype=torch.bfloat16) * 0.4)(B, Hkv, Sk, Dh)),
            "wq": _w((lambda *s: torch.randn(*s, dtype=torch.bfloat16) * 3.2)(D, Hq * Dh) * (D ** -0.5)),
            "wo": _w((lambda *s: torch.randn(*s, dtype=torch.bfloat16) * 0.4)(Hq * Dh, D) * ((Hq * Dh) ** -0.5)),
        }
    _A_in = _A_setup()

    def _B_setup():
        B, S, D, F = 8, 1, 576, 4608
        return {
            "x": _w((lambda *s: torch.randn(*s, dtype=torch.bfloat16) * 0.05)(B, S, D)),
            "w_gate": _w((lambda *s: torch.randn(*s, dtype=torch.bfloat16) * 0.05)(D, F)),
            "w_up": _w((lambda *s: torch.randn(*s, dtype=torch.bfloat16) * 0.05)(D, F)),
            "w_down": _w((lambda *s: torch.randn(*s, dtype=torch.bfloat16) * 0.05)(F, D)),
        }
    _B_in = _B_setup()

    return {
        "A_x": _A_in["x"],
        "A_k_cache": _A_in["k_cache"],
        "A_v_cache": _A_in["v_cache"],
        "A_wq": _A_in["wq"],
        "A_wo": _A_in["wo"],
        "B_x": _B_in["x"],
        "B_w_gate": _B_in["w_gate"],
        "B_w_up": _B_in["w_up"],
        "B_w_down": _B_in["w_down"],
        "gate_w": _w((lambda *s: torch.randn(*s, dtype=torch.bfloat16) * 0.05)(576) * 16.0),
    }

def reference(A_x, A_k_cache, A_v_cache, A_wq, A_wo, B_x, B_w_gate, B_w_up, B_w_down, gate_w):
    def _A_ref(x, k_cache, v_cache, wq, wo):
        B, Sq, D = x.shape
        Hq, Dh = 32, 128
        Hkv, Sk = k_cache.shape[1], k_cache.shape[2]
        W = min(4096, max(256, Sk // 4))
        rep = Hq // Hkv
        q = (lambda x, *d: x.permute(*d))((x @ wq).reshape(B, Sq, Hq, Dh), 0, 2, 1, 3)
        k = (lambda x, n, axis: torch.repeat_interleave(x, n, dim=axis))(k_cache[:, :, Sk - W:, :], rep, axis=1)
        v = (lambda x, n, axis: torch.repeat_interleave(x, n, dim=axis))(v_cache[:, :, Sk - W:, :], rep, axis=1)
        scores = torch.einsum("bhqd,bhkd->bhqk", q, k) * (Dh ** -0.5)
        p = _softmax(scores, axis=-1)
        o = torch.einsum("bhqk,bhkd->bhqd", p, v)
        return (lambda x, *d: x.permute(*d))(o, 0, 2, 1, 3).reshape(B, Sq, Hq * Dh) @ wo

    def _B_ref(x, w_gate, w_up, w_down):
        g = _silu(x @ w_gate)
        u = x @ w_up
        return (g * u) @ w_down

    x = A_x
    g = _sigmoid((x * gate_w).sum(-1, keepdims=True))
    a = _A_ref(x, A_k_cache, A_v_cache, A_wq, A_wo)
    b = _B_ref(x, B_w_gate, B_w_up, B_w_down)
    return g * a + (1 - g) * b
```

```asm
; @launch grid=(256,1,1) block=(1024,1,1) lds=143360
.amdgcn_target "amdgcn-amd-amdhsa--gfx950"
.text
.globl gated_mix__sliding_block_cached__swiglu_ffn__decode_kernel
.p2align 8
.type gated_mix__sliding_block_cached__swiglu_ffn__decode_kernel,@function
gated_mix__sliding_block_cached__swiglu_ffn__decode_kernel:
    s_cmp_ge_u32 s2, 256
    s_cbranch_scc1 L_END
    s_load_dwordx16 s[16:31], s[0:1], 0
    s_load_dwordx8 s[32:39], s[0:1], 64
    s_load_dwordx2 s[40:41], s[0:1], 96
    s_and_b32 s99, s2, 7
    s_lshl_b32 s99, s99, 3
    s_mov_b32 s56, 0x0c000c00
    s_mov_b32 s57, 0x0c000c00
    s_lshr_b64 s[56:57], s[56:57], s99
    s_and_b32 s60, s56, 0xff
    s_mov_b32 s56, 0x0c0c0000
    s_mov_b32 s57, 0x24241818
    s_lshr_b64 s[56:57], s[56:57], s99
    s_and_b32 s61, s56, 0xff
    s_mov_b32 s56, 0x42172e00
    s_mov_b32 s57, 0xa2867256
    s_lshr_b64 s[56:57], s[56:57], s99
    s_and_b32 s62, s56, 0xff
    s_mov_b32 s56, 0x0f170f17
    s_mov_b32 s57, 0x0f1c0f1c
    s_lshr_b64 s[56:57], s[56:57], s99
    s_and_b32 s63, s56, 0xff
    s_mov_b32 s56, 0x3d261700
    s_mov_b32 s57, 0x9377684c
    s_lshr_b64 s[56:57], s[56:57], s99
    s_and_b32 s64, s56, 0xff
    s_mov_b32 s56, 0x00090009
    s_mov_b32 s57, 0x00040004
    s_lshr_b64 s[56:57], s[56:57], s99
    s_and_b32 s66, s56, 0xff
    s_mov_b32 s56, 0x12090900
    s_mov_b32 s57, 0x1a161612
    s_lshr_b64 s[56:57], s[56:57], s99
    s_and_b32 s67, s56, 0xff
    s_lshr_b32 s65, s2, 3
    s_add_u32 s98, s61, s65
    s_mov_b32 s99, 255
    s_cmp_lt_u32 s65, s60
    s_cbranch_scc1 L_ROLE
    s_sub_u32 s65, s65, s60
    s_sub_u32 s69, s65, s66
    s_add_u32 s68, s64, s69
    s_cmp_lt_u32 s69, s63
    s_cselect_b32 s99, s68, 255
    s_add_u32 s98, s67, s65
    s_lshl_b32 s98, s98, 3
    s_add_u32 s98, s98, 51
    s_cmp_lt_u32 s65, s66
    s_cbranch_scc1 L_ROLE
    s_add_u32 s68, s62, s65
    s_sub_u32 s68, s68, s66
    s_mul_i32 s69, s68, 9363
    s_lshr_b32 s69, s69, 16
    s_mul_i32 s70, s69, 7
    s_sub_u32 s68, s68, s70
    s_lshl_b32 s98, s69, 3
    s_add_u32 s98, s98, s68
    s_cmp_ge_u32 s68, 3
    s_addc_u32 s98, s98, 48
L_ROLE:
    v_and_b32 v1, 63, v0
    v_lshrrev_b32 v9, 6, v0
    v_lshlrev_b32 v3, 2, v0
    v_add_u32 v3, 131072, v3
    v_mov_b32 v4, 0
    v_mov_b32 v5, 0xff800000
    v_cmp_le_u32 vcc, 1022, v0
    v_readfirstlane_b32 s3, v9
    s_nop 0
    v_cndmask_b32 v4, v4, v5, vcc
    s_xor_b32 s3, s3, 8
    ds_write_b32 v3, v4
    s_cmp_eq_u32 s3, 7
    s_cbranch_scc0 L_NOCPF
    s_cmp_lt_u32 s2, 16
    s_cbranch_scc0 L_NOCPF
    s_getpc_b64 s[12:13]
L_CPFPC:
    s_sub_u32 s12, s12, L_CPFPC-gated_mix__sliding_block_cached__swiglu_ffn__decode_kernel
    s_subb_u32 s13, s13, 0
    v_lshlrev_b32 v10, 7, v1
    s_lshr_b32 s14, s2, 3
    s_lshl_b32 s14, s14, 13
    v_add_u32 v10, s14, v10
    v_cmp_gt_u32 vcc, L_END-gated_mix__sliding_block_cached__swiglu_ffn__decode_kernel, v10
    s_and_b64 exec, exec, vcc
    global_load_dword v48, v10, s[12:13]
    s_mov_b64 exec, -1
L_NOCPF:
    v_and_b32 v6, 15, v1
    v_lshrrev_b32 v7, 4, v1
    v_lshlrev_b32 v8, 4, v1
    v_lshlrev_b32 v9, 12, v7
    v_lshl_add_u32 v9, v6, 4, v9
    s_lshr_b32 s4, s2, 5
    s_and_b32 s5, s2, 15
    s_lshl_b32 s6, s4, 4
    s_add_u32 s6, s6, s5
    s_lshl_b32 s6, s6, 20
    s_lshr_b32 s7, s2, 4
    s_and_b32 s7, s7, 1
    s_lshl_b32 s7, s7, 17
    s_add_u32 s6, s6, s7
    s_add_u32 s6, s6, 0xC0000
    s_add_u32 s7, s3, s2
    s_and_b32 s7, s7, 7
    s_lshl_b32 s7, s7, 14
    s_add_u32 s6, s6, s7
    s_add_u32 s7, s6, 4096
    s_add_u32 s8, s6, 8192
    s_add_u32 s9, s6, 12288
    s_and_b32 s10, s3, 7
    s_sub_u32 s11, s98, 48
    s_cmp_ge_u32 s3, 8
    s_cbranch_scc1 L_VPRO
    s_waitcnt lgkmcnt(0)
    s_load_dword s42, s[40:41], 0
    s_mov_b32 s44, s40
    s_mov_b32 s45, s41
    s_mov_b32 s46, 4194304
    s_mov_b32 s47, 0x00020000
    s_branch L_KWAVE
L_VPRO:
    v_and_b32 v10, 7, v6
    v_mul_u32_u24 v10, 1152, v10
    v_lshlrev_b32 v11, 4, v7
    v_add_u32 v10, v10, v11
    s_mul_i32 s14, s10, 192
    v_add_u32 v10, s14, v10
    s_mov_b32 s12, 8192
    s_mov_b32 s13, s11
    s_mov_b32 s54, 4718592
    s_cmp_lt_i32 s11, 64
    s_cbranch_scc1 L_S1SEL0
    s_mov_b32 s54, 5308416
    s_mov_b32 s12, 9216
    s_sub_u32 s13, s11, 64
    s_cmp_lt_u32 s11, 136
    s_cbranch_scc1 L_S1SEL0
    s_sub_u32 s13, s11, 136
L_S1SEL0:
    s_mov_b32 s55, 0x00020000
    s_lshl_b32 s13, s13, 7
    v_lshrrev_b32 v14, 3, v1
    v_mul_lo_u32 v12, v14, s12
    v_and_b32 v14, 1, v7
    v_lshlrev_b32 v14, 1, v14
    v_and_b32 v13, 7, v1
    v_xor_b32 v14, v14, v13
    v_lshlrev_b32 v13, 4, v14
    v_add_u32 v12, v12, v13
    v_xor_b32 v13, 64, v12
    s_mul_i32 s14, s10, 96
    s_mul_i32 s14, s14, s12
    s_add_u32 s14, s14, s13
    s_lshl_b32 s15, s12, 3
    s_mul_i32 s56, s10, 12288
    s_waitcnt lgkmcnt(0)
    s_load_dword s42, s[40:41], 0
    s_mov_b32 s44, s40
    s_mov_b32 s45, s41
    s_mov_b32 s46, 4194304
    s_mov_b32 s47, 0x00020000
L_VWAVE:
    s_mov_b32 s48, s20
    s_mov_b32 s49, s21
    s_mov_b32 s50, 0x8000000
    s_mov_b32 s51, 0x00020000
    s_cmp_lt_u32 s98, 48
    s_cbranch_scc1 L_VBAR
    s_cmp_ge_u32 s10, 6
    s_cbranch_scc1 L_VBAR
    s_setprio 3
    s_mov_b32 s52, s22
    s_mov_b32 s53, s23
    s_cmp_lt_u32 s11, 64
    s_cbranch_scc1 L_S1SEL
    s_mov_b32 s52, s28
    s_mov_b32 s53, s29
    s_cmp_lt_u32 s11, 136
    s_cbranch_scc1 L_S1SEL
    s_mov_b32 s52, s30
    s_mov_b32 s53, s31
L_S1SEL:
    s_add_u32 m0, s56, 0
    s_nop 0
    buffer_load_dwordx4 v12, s[52:55], s14 offen nt lds
    s_add_u32 m0, s56, 1024
    s_add_u32 s14, s14, s15
    buffer_load_dwordx4 v13, s[52:55], s14 offen nt lds
    s_add_u32 m0, s56, 2048
    s_add_u32 s14, s14, s15
    buffer_load_dwordx4 v12, s[52:55], s14 offen nt lds
    s_add_u32 m0, s56, 3072
    s_add_u32 s14, s14, s15
    buffer_load_dwordx4 v13, s[52:55], s14 offen nt lds
    s_add_u32 m0, s56, 4096
    s_add_u32 s14, s14, s15
    buffer_load_dwordx4 v12, s[52:55], s14 offen nt lds
    s_add_u32 m0, s56, 5120
    s_add_u32 s14, s14, s15
    buffer_load_dwordx4 v13, s[52:55], s14 offen nt lds
    s_add_u32 m0, s56, 6144
    s_add_u32 s14, s14, s15
    buffer_load_dwordx4 v12, s[52:55], s14 offen nt lds
    s_add_u32 m0, s56, 7168
    s_add_u32 s14, s14, s15
    buffer_load_dwordx4 v13, s[52:55], s14 offen nt lds
    s_add_u32 m0, s56, 8192
    s_add_u32 s14, s14, s15
    buffer_load_dwordx4 v12, s[52:55], s14 offen nt lds
    s_add_u32 m0, s56, 9216
    s_add_u32 s14, s14, s15
    buffer_load_dwordx4 v13, s[52:55], s14 offen nt lds
    s_add_u32 m0, s56, 10240
    s_add_u32 s14, s14, s15
    buffer_load_dwordx4 v12, s[52:55], s14 offen nt lds
    s_add_u32 m0, s56, 11264
    s_add_u32 s14, s14, s15
    buffer_load_dwordx4 v13, s[52:55], s14 offen nt lds
    global_load_dwordx4 v[16:19], v10, s[16:17] offset:0
    global_load_dwordx4 v[20:23], v10, s[16:17] offset:64
    global_load_dwordx4 v[24:27], v10, s[16:17] offset:128
    s_barrier
    v_lshrrev_b32 v28, 2, v6
    v_lshlrev_b32 v31, 3, v7
    v_add_u32 v31, v31, v28
    v_lshlrev_b32 v31, 7, v31
    v_lshrrev_b32 v28, 1, v28
    v_and_b32 v29, 1, v7
    v_lshlrev_b32 v29, 1, v29
    v_or_b32 v28, v28, v29
    v_lshlrev_b32 v28, 5, v28
    v_add_u32 v31, v31, v28
    v_and_b32 v28, 3, v6
    v_lshlrev_b32 v28, 3, v28
    v_add_u32 v28, v31, v28
    v_add_u32 v28, s56, v28
    v_xor_b32 v29, 32, v28
    v_xor_b32 v30, 64, v28
    v_xor_b32 v31, 0x60, v28
    s_waitcnt vmcnt(0)
    ds_read_b64_tr_b16 v[48:49], v28 offset:0
    ds_read_b64_tr_b16 v[50:51], v28 offset:512
    ds_read_b64_tr_b16 v[52:53], v29 offset:0
    ds_read_b64_tr_b16 v[54:55], v29 offset:512
    ds_read_b64_tr_b16 v[56:57], v30 offset:0
    ds_read_b64_tr_b16 v[58:59], v30 offset:512
    ds_read_b64_tr_b16 v[60:61], v31 offset:0
    ds_read_b64_tr_b16 v[62:63], v31 offset:512
    s_waitcnt lgkmcnt(7)
    ds_read_b64_tr_b16 v[64:65], v28 offset:4096
    ds_read_b64_tr_b16 v[66:67], v28 offset:4608
    ds_read_b64_tr_b16 v[68:69], v29 offset:4096
    ds_read_b64_tr_b16 v[70:71], v29 offset:4608
    ds_read_b64_tr_b16 v[72:73], v30 offset:4096
    ds_read_b64_tr_b16 v[74:75], v30 offset:4608
    ds_read_b64_tr_b16 v[76:77], v31 offset:4096
    ds_read_b64_tr_b16 v[78:79], v31 offset:4608
    s_waitcnt lgkmcnt(8)
    v_mfma_f32_16x16x32_bf16 v[32:35], v[48:51], v[16:19], 0
    v_mfma_f32_16x16x32_bf16 v[36:39], v[52:55], v[16:19], 0
    v_mfma_f32_16x16x32_bf16 v[40:43], v[56:59], v[16:19], 0
    v_mfma_f32_16x16x32_bf16 v[44:47], v[60:63], v[16:19], 0
    ds_read_b64_tr_b16 v[80:81], v28 offset:8192
    ds_read_b64_tr_b16 v[82:83], v28 offset:8704
    ds_read_b64_tr_b16 v[84:85], v29 offset:8192
    ds_read_b64_tr_b16 v[86:87], v29 offset:8704
    ds_read_b64_tr_b16 v[88:89], v30 offset:8192
    ds_read_b64_tr_b16 v[90:91], v30 offset:8704
    ds_read_b64_tr_b16 v[92:93], v31 offset:8192
    ds_read_b64_tr_b16 v[94:95], v31 offset:8704
    s_waitcnt lgkmcnt(8)
    v_mfma_f32_16x16x32_bf16 v[32:35], v[64:67], v[20:23], v[32:35]
    v_mfma_f32_16x16x32_bf16 v[36:39], v[68:71], v[20:23], v[36:39]
    v_mfma_f32_16x16x32_bf16 v[40:43], v[72:75], v[20:23], v[40:43]
    v_mfma_f32_16x16x32_bf16 v[44:47], v[76:79], v[20:23], v[44:47]
    s_waitcnt lgkmcnt(0)
    v_mfma_f32_16x16x32_bf16 v[32:35], v[80:83], v[24:27], v[32:35]
    v_mfma_f32_16x16x32_bf16 v[36:39], v[84:87], v[24:27], v[36:39]
    v_mfma_f32_16x16x32_bf16 v[40:43], v[88:91], v[24:27], v[40:43]
    v_mfma_f32_16x16x32_bf16 v[44:47], v[92:95], v[24:27], v[44:47]
    v_lshlrev_b32 v10, 3, v7
    v_add_u32 v10, v10, v6
    v_lshlrev_b32 v10, 4, v10
    s_lshl_b32 s14, s10, 11
    s_add_u32 s14, s14, 73728
    v_add_u32 v10, s14, v10
    s_mov_b32 s58, 0x00ff00ff
    s_mov_b32 s59, 0x00ff00ff
    s_nop 1
    s_mov_b64 exec, s[58:59]
    ds_write_b128 v10, v[32:35] offset:0
    ds_write_b128 v10, v[36:39] offset:512
    ds_write_b128 v10, v[40:43] offset:1024
    ds_write_b128 v10, v[44:47] offset:1536
    s_mov_b64 exec, -1
    s_waitcnt lgkmcnt(0)
    s_mov_b64 s[58:59], exec
    s_mov_b64 exec, 1
    v_mov_b32 v10, 134176
    v_mov_b32 v11, 1
    ds_add_rtn_u32 v12, v10, v11
    s_waitcnt lgkmcnt(0)
    v_readfirstlane_b32 s56, v12
    s_mov_b64 exec, s[58:59]
    s_cmp_eq_u32 s56, 5
    s_cbranch_scc0 L_S1DONE
    v_and_b32 v10, 31, v1
    v_lshlrev_b32 v10, 4, v10
    v_lshrrev_b32 v11, 5, v1
    v_lshlrev_b32 v12, 9, v11
    v_add_u32 v10, v10, v12
    v_add_u32 v10, 73728, v10
    ds_read_b128 v[48:51], v10 offset:0
    ds_read_b128 v[52:55], v10 offset:1024
    ds_read_b128 v[56:59], v10 offset:2048
    ds_read_b128 v[60:63], v10 offset:3072
    ds_read_b128 v[64:67], v10 offset:4096
    ds_read_b128 v[68:71], v10 offset:5120
    ds_read_b128 v[72:75], v10 offset:6144
    ds_read_b128 v[76:79], v10 offset:7168
    ds_read_b128 v[80:83], v10 offset:8192
    ds_read_b128 v[84:87], v10 offset:9216
    ds_read_b128 v[88:91], v10 offset:10240
    ds_read_b128 v[92:95], v10 offset:11264
    v_and_b32 v12, 7, v1
    s_mov_b32 s14, 53248
    v_mul_lo_u32 v12, v12, s14
    v_bfe_u32 v13, v1, 3, 2
    v_lshlrev_b32 v14, 2, v11
    v_add_u32 v13, v13, v14
    v_lshlrev_b32 v13, 4, v13
    v_add_u32 v12, v12, v13
    s_lshl_b32 s14, s11, 8
    s_add_u32 s14, s14, 65536
    s_waitcnt lgkmcnt(0)
    s_mul_i32 s43, s42, 0x9E3779B1
    s_add_u32 s43, s43, 0x7F4A7C15
    v_add_f32 v16, v48, v56
    v_add_f32 v64, v64, v72
    v_add_f32 v80, v80, v88
    v_add_f32 v16, v16, v64
    v_add_f32 v16, v16, v80
    v_add_f32 v17, v49, v57
    v_add_f32 v65, v65, v73
    v_add_f32 v81, v81, v89
    v_add_f32 v17, v17, v65
    v_add_f32 v17, v17, v81
    v_add_f32 v18, v50, v58
    v_add_f32 v66, v66, v74
    v_add_f32 v82, v82, v90
    v_add_f32 v18, v18, v66
    v_add_f32 v18, v18, v82
    v_add_f32 v19, v51, v59
    v_add_f32 v67, v67, v75
    v_add_f32 v83, v83, v91
    v_add_f32 v19, v19, v67
    v_add_f32 v19, v19, v83
    v_add_f32 v20, v52, v60
    v_add_f32 v68, v68, v76
    v_add_f32 v84, v84, v92
    v_add_f32 v20, v20, v68
    v_add_f32 v20, v20, v84
    v_add_f32 v21, v53, v61
    v_add_f32 v69, v69, v77
    v_add_f32 v85, v85, v93
    v_add_f32 v21, v21, v69
    v_add_f32 v21, v21, v85
    v_add_f32 v22, v54, v62
    v_add_f32 v70, v70, v78
    v_add_f32 v86, v86, v94
    v_add_f32 v22, v22, v70
    v_add_f32 v22, v22, v86
    v_add_f32 v23, v55, v63
    v_add_f32 v71, v71, v79
    v_add_f32 v87, v87, v95
    v_add_f32 v23, v23, v71
    v_add_f32 v23, v23, v87
    v_mov_b32 v25, s43
    v_mov_b32 v27, s43
    v_mov_b32 v29, s43
    v_mov_b32 v31, s43
    v_cvt_pk_bf16_f32 v24, v16, v17
    v_cvt_pk_bf16_f32 v26, v18, v19
    v_cvt_pk_bf16_f32 v28, v20, v21
    v_cvt_pk_bf16_f32 v30, v22, v23
    buffer_store_dwordx4 v[24:27], v12, s[44:47], s14 offen sc1
    buffer_store_dwordx4 v[28:31], v12, s[44:47], s14 offen offset:128 sc1
    s_mov_b64 s[58:59], exec
    s_mov_b64 exec, 1
    v_mov_b32 v10, 134204
    v_mov_b32 v11, 1
    ds_add_u32 v10, v11
    s_mov_b64 exec, s[58:59]
L_S1DONE:
    s_setprio 1
    s_branch L_VGATE
L_VBAR:
    s_setprio 1
    s_barrier
    s_cmp_lt_u32 s3, 14
    s_cbranch_scc1 L_VGATE
    s_waitcnt lgkmcnt(0)
    s_mul_i32 s43, s42, 0x9E3779B1
    s_add_u32 s43, s43, 0x7F4A7C15
    s_sub_u32 s15, s3, 12
    s_mul_i32 s14, s4, 53248
    s_lshl_b32 s12, s5, 10
    s_add_u32 s14, s14, s12
    s_lshl_b32 s12, s15, 8
    s_add_u32 s14, s14, s12
    s_add_u32 s14, s14, 65536
    s_add_u32 s12, s40, s14
    s_addc_u32 s13, s41, 0
    s_mov_b32 s11, 0
L_qf_1:
    s_load_dwordx16 s[16:31], s[12:13], 0 glc
    s_load_dwordx16 s[56:71], s[12:13], 64 glc
    s_load_dwordx16 s[72:87], s[12:13], 128 glc
    s_load_dwordx8 s[32:39], s[12:13], 192 glc
    s_load_dwordx8 s[88:95], s[12:13], 224 glc
    s_add_u32 s11, s11, 1
    s_cmp_ge_u32 s11, 0x8000
    s_cbranch_scc1 L_qf_1_go
    s_waitcnt lgkmcnt(0)
    s_xor_b32 s14, s31, s43
    s_xor_b32 s100, s71, s43
    s_or_b32 s14, s14, s100
    s_xor_b32 s100, s87, s43
    s_or_b32 s14, s14, s100
    s_xor_b32 s100, s39, s43
    s_or_b32 s14, s14, s100
    s_xor_b32 s100, s95, s43
    s_or_b32 s14, s14, s100
    s_cbranch_scc1 L_qf_1
    v_writelane_b32 v24, s16, 0
    v_writelane_b32 v24, s17, 1
    v_writelane_b32 v24, s18, 2
    v_writelane_b32 v24, s19, 3
    v_writelane_b32 v24, s20, 4
    v_writelane_b32 v24, s21, 5
    v_writelane_b32 v24, s22, 6
    v_writelane_b32 v24, s23, 7
    v_writelane_b32 v24, s24, 8
    v_writelane_b32 v24, s25, 9
    v_writelane_b32 v24, s26, 10
    v_writelane_b32 v24, s27, 11
    v_writelane_b32 v24, s28, 12
    v_writelane_b32 v24, s29, 13
    v_writelane_b32 v24, s30, 14
    v_writelane_b32 v24, s31, 15
    v_writelane_b32 v24, s56, 16
    v_writelane_b32 v24, s57, 17
    v_writelane_b32 v24, s58, 18
    v_writelane_b32 v24, s59, 19
    v_writelane_b32 v24, s60, 20
    v_writelane_b32 v24, s61, 21
    v_writelane_b32 v24, s62, 22
    v_writelane_b32 v24, s63, 23
    v_writelane_b32 v24, s64, 24
    v_writelane_b32 v24, s65, 25
    v_writelane_b32 v24, s66, 26
    v_writelane_b32 v24, s67, 27
    v_writelane_b32 v24, s68, 28
    v_writelane_b32 v24, s69, 29
    v_writelane_b32 v24, s70, 30
    v_writelane_b32 v24, s71, 31
    v_writelane_b32 v24, s72, 32
    v_writelane_b32 v24, s73, 33
    v_writelane_b32 v24, s74, 34
    v_writelane_b32 v24, s75, 35
    v_writelane_b32 v24, s76, 36
    v_writelane_b32 v24, s77, 37
    v_writelane_b32 v24, s78, 38
    v_writelane_b32 v24, s79, 39
    v_writelane_b32 v24, s80, 40
    v_writelane_b32 v24, s81, 41
    v_writelane_b32 v24, s82, 42
    v_writelane_b32 v24, s83, 43
    v_writelane_b32 v24, s84, 44
    v_writelane_b32 v24, s85, 45
    v_writelane_b32 v24, s86, 46
    v_writelane_b32 v24, s87, 47
    v_writelane_b32 v24, s32, 48
    v_writelane_b32 v24, s33, 49
    v_writelane_b32 v24, s34, 50
    v_writelane_b32 v24, s35, 51
    v_writelane_b32 v24, s36, 52
    v_writelane_b32 v24, s37, 53
    v_writelane_b32 v24, s38, 54
    v_writelane_b32 v24, s39, 55
    v_writelane_b32 v24, s88, 56
    v_writelane_b32 v24, s89, 57
    v_writelane_b32 v24, s90, 58
    v_writelane_b32 v24, s91, 59
    v_writelane_b32 v24, s92, 60
    v_writelane_b32 v24, s93, 61
    v_writelane_b32 v24, s94, 62
    v_writelane_b32 v24, s95, 63
    s_mov_b32 s100, 0xaaaaaaaa
    s_mov_b32 s101, 0xaaaaaaaa
    s_nop 0
    v_cmp_ne_u32 vcc, s43, v24
    s_and_b64 vcc, vcc, s[100:101]
    s_cbranch_vccnz L_qf_1
L_qf_1_go:
    s_waitcnt lgkmcnt(0)
    v_lshrrev_b32 v25, 1, v1
    v_lshlrev_b32 v25, 2, v25
    s_lshl_b32 s14, s15, 7
    s_add_u32 s14, s14, 135168
    v_add_u32 v25, s14, v25
    s_mov_b32 s100, 0x55555555
    s_mov_b32 s101, 0x55555555
    s_mov_b64 exec, s[100:101]
    ds_write_b32 v25, v24
    s_mov_b64 exec, -1
    s_load_dwordx16 s[16:31], s[0:1], 0
    s_load_dwordx8 s[32:39], s[0:1], 64
    s_waitcnt lgkmcnt(0)
    s_mov_b64 s[58:59], exec
    s_mov_b64 exec, 1
    v_mov_b32 v25, 134180
    v_mov_b32 v26, 1
    ds_add_u32 v25, v26
    s_mov_b64 exec, s[58:59]
L_VGATE:
    v_mov_b32 v23, 134240
    s_mov_b32 s57, 0
L_lw_2:
    ds_read_b32 v22, v23
    s_waitcnt lgkmcnt(0)
    v_readfirstlane_b32 s56, v22
    s_add_u32 s57, s57, 1
    s_cmp_ge_u32 s56, 8
    s_cbranch_scc1 L_lwd_3
    s_sleep 1
    s_cmp_lt_u32 s57, 0x40000
    s_cbranch_scc1 L_lw_2
L_lwd_3:
    s_mov_b32 s61, 0
    buffer_load_dwordx4 v[48:51], v9, s[48:51], s6 offen offset:0 nt
    buffer_load_dwordx4 v[52:55], v9, s[48:51], s6 offen offset:256 nt
    buffer_load_dwordx4 v[56:59], v9, s[48:51], s6 offen offset:512 nt
    buffer_load_dwordx4 v[60:63], v9, s[48:51], s6 offen offset:768 nt
    buffer_load_dwordx4 v[64:67], v9, s[48:51], s6 offen offset:1024 nt
    buffer_load_dwordx4 v[68:71], v9, s[48:51], s6 offen offset:1280 nt
    buffer_load_dwordx4 v[72:75], v9, s[48:51], s6 offen offset:1536 nt
    buffer_load_dwordx4 v[76:79], v9, s[48:51], s6 offen offset:1792 nt
    buffer_load_dwordx4 v[80:83], v9, s[48:51], s6 offen offset:2048 nt
    buffer_load_dwordx4 v[84:87], v9, s[48:51], s6 offen offset:2304 nt
    buffer_load_dwordx4 v[88:91], v9, s[48:51], s6 offen offset:2560 nt
    buffer_load_dwordx4 v[92:95], v9, s[48:51], s6 offen offset:2816 nt
    buffer_load_dwordx4 v[96:99], v9, s[48:51], s6 offen offset:3072 nt
    buffer_load_dwordx4 v[100:103], v9, s[48:51], s6 offen offset:3328 nt
    buffer_load_dwordx4 v[104:107], v9, s[48:51], s6 offen offset:3584 nt
    buffer_load_dwordx4 v[108:111], v9, s[48:51], s6 offen offset:3840 nt
    s_mov_b64 s[58:59], exec
    s_mov_b64 exec, 1
    v_mov_b32 v22, 134200
    v_mov_b32 v23, 1
    ds_add_u32 v22, v23
    s_mov_b64 exec, s[58:59]
    s_lshl_b32 s14, s10, 8
    s_add_u32 s14, s14, 135680
    v_and_b32 v10, 1, v6
    v_lshlrev_b32 v10, 7, v10
    v_lshlrev_b32 v11, 4, v7
    v_add_u32 v10, v10, v11
    v_add_u32 v10, s14, v10
    v_mov_b32 v11, 134272
    v_and_b32 v16, 14, v6
    v_cmp_eq_u32 vcc, 0, v16
    s_nop 1
    v_cndmask_b32 v12, v11, v10, vcc
    v_cmp_eq_u32 vcc, 4, v16
    s_nop 1
    v_cndmask_b32 v13, v11, v10, vcc
    v_cmp_eq_u32 vcc, 8, v16
    s_nop 1
    v_cndmask_b32 v14, v11, v10, vcc
    v_cmp_eq_u32 vcc, 12, v16
    s_nop 1
    v_cndmask_b32 v15, v11, v10, vcc
    v_lshlrev_b32 v10, 3, v6
    v_add_u32 v10, v10, v7
    v_lshlrev_b32 v10, 2, v10
    s_lshl_b32 s14, s10, 10
    s_add_u32 s14, s14, 98304
    v_add_u32 v10, s14, v10
    s_mov_b32 s12, 0x05040100
    s_mov_b32 s13, 0x07060302
    s_lshl_b32 s60, s5, 10
    s_lshl_b32 s14, s4, 7
    s_add_u32 s60, s60, s14
    s_lshr_b32 s14, s2, 4
    s_and_b32 s14, s14, 1
    s_lshl_b32 s14, s14, 2
    s_add_u32 s60, s60, s14
    s_add_u32 s60, s60, 16384
    s_waitcnt lgkmcnt(0)
    s_mul_i32 s43, s42, 0x9E3779B1
    s_add_u32 s43, s43, 0x7F4A7C15
    v_mov_b32 v11, s43
    s_lshl_b32 s14, s10, 2
    s_add_u32 s14, s14, 134208
    v_mov_b32 v18, s14
    s_mov_b32 s57, 0
L_pw_4:
    ds_read_b32 v17, v18
    s_waitcnt lgkmcnt(0)
    v_readfirstlane_b32 s56, v17
    s_add_u32 s57, s57, 1
    s_cmp_ge_u32 s56, 1
    s_cbranch_scc1 L_pw_4_d
    s_sleep 2
    s_cmp_lt_u32 s57, 0x40000
    s_cbranch_scc1 L_pw_4
L_pw_4_d:
    ds_read_b128 v[28:31], v12
    ds_read_b128 v[32:35], v13
    ds_read_b128 v[36:39], v14
    ds_read_b128 v[40:43], v15
    s_waitcnt vmcnt(8)
    v_perm_b32 v112, v52, v48, s12
    v_perm_b32 v113, v60, v56, s12
    v_perm_b32 v114, v68, v64, s12
    v_perm_b32 v115, v76, v72, s12
    v_perm_b32 v116, v52, v48, s13
    v_perm_b32 v117, v60, v56, s13
    v_perm_b32 v118, v68, v64, s13
    v_perm_b32 v119, v76, v72, s13
    v_perm_b32 v44, v53, v49, s12
    v_perm_b32 v45, v61, v57, s12
    v_perm_b32 v46, v69, v65, s12
    v_perm_b32 v47, v77, v73, s12
    v_perm_b32 v16, v53, v49, s13
    v_perm_b32 v17, v61, v57, s13
    v_perm_b32 v18, v69, v65, s13
    v_perm_b32 v19, v77, v73, s13
    s_waitcnt lgkmcnt(0)
    v_mfma_f32_16x16x32_bf16 v[20:23], v[28:31], v[112:115], 0
    v_mfma_f32_16x16x32_bf16 v[20:23], v[32:35], v[116:119], v[20:23]
    v_mfma_f32_16x16x32_bf16 v[20:23], v[36:39], v[44:47], v[20:23]
    v_mfma_f32_16x16x32_bf16 v[20:23], v[40:43], v[16:19], v[20:23]
    v_perm_b32 v112, v54, v50, s12
    v_perm_b32 v113, v62, v58, s12
    v_perm_b32 v114, v70, v66, s12
    v_perm_b32 v115, v78, v74, s12
    v_perm_b32 v116, v54, v50, s13
    v_perm_b32 v117, v62, v58, s13
    v_perm_b32 v118, v70, v66, s13
    v_perm_b32 v119, v78, v74, s13
    v_perm_b32 v44, v55, v51, s12
    v_perm_b32 v45, v63, v59, s12
    v_perm_b32 v46, v71, v67, s12
    v_perm_b32 v47, v79, v75, s12
    v_perm_b32 v16, v55, v51, s13
    v_perm_b32 v17, v63, v59, s13
    v_perm_b32 v18, v71, v67, s13
    v_perm_b32 v19, v79, v75, s13
    s_nop 1
    v_mfma_f32_16x16x32_bf16 v[24:27], v[28:31], v[112:115], 0
    v_mfma_f32_16x16x32_bf16 v[24:27], v[32:35], v[116:119], v[24:27]
    v_mfma_f32_16x16x32_bf16 v[24:27], v[36:39], v[44:47], v[24:27]
    v_mfma_f32_16x16x32_bf16 v[24:27], v[40:43], v[16:19], v[24:27]
    s_nop 7
    ds_read_b128 v[28:31], v12 offset:64
    ds_read_b128 v[32:35], v13 offset:64
    ds_read_b128 v[36:39], v14 offset:64
    ds_read_b128 v[40:43], v15 offset:64
    s_waitcnt vmcnt(6)
    v_perm_b32 v48, v84, v80, s12
    v_perm_b32 v52, v84, v80, s13
    v_perm_b32 v56, v85, v81, s12
    v_perm_b32 v60, v85, v81, s13
    v_perm_b32 v64, v86, v82, s12
    v_perm_b32 v68, v86, v82, s13
    v_perm_b32 v72, v87, v83, s12
    v_perm_b32 v76, v87, v83, s13
    s_waitcnt vmcnt(4)
    v_perm_b32 v49, v92, v88, s12
    v_perm_b32 v53, v92, v88, s13
    v_perm_b32 v57, v93, v89, s12
    v_perm_b32 v61, v93, v89, s13
    v_perm_b32 v65, v94, v90, s12
    v_perm_b32 v69, v94, v90, s13
    v_perm_b32 v73, v95, v91, s12
    v_perm_b32 v77, v95, v91, s13
    s_waitcnt vmcnt(2)
    v_perm_b32 v50, v100, v96, s12
    v_perm_b32 v54, v100, v96, s13
    v_perm_b32 v58, v101, v97, s12
    v_perm_b32 v62, v101, v97, s13
    v_perm_b32 v66, v102, v98, s12
    v_perm_b32 v70, v102, v98, s13
    v_perm_b32 v74, v103, v99, s12
    v_perm_b32 v78, v103, v99, s13
    s_waitcnt vmcnt(0)
    v_perm_b32 v51, v108, v104, s12
    v_perm_b32 v55, v108, v104, s13
    v_perm_b32 v59, v109, v105, s12
    v_perm_b32 v63, v109, v105, s13
    v_perm_b32 v67, v110, v106, s12
    v_perm_b32 v71, v110, v106, s13
    v_perm_b32 v75, v111, v107, s12
    v_perm_b32 v79, v111, v107, s13
    s_waitcnt lgkmcnt(0)
    v_mfma_f32_16x16x32_bf16 v[20:23], v[28:31], v[48:51], v[20:23]
    v_mfma_f32_16x16x32_bf16 v[24:27], v[28:31], v[64:67], v[24:27]
    v_mfma_f32_16x16x32_bf16 v[20:23], v[32:35], v[52:55], v[20:23]
    v_mfma_f32_16x16x32_bf16 v[24:27], v[32:35], v[68:71], v[24:27]
    v_mfma_f32_16x16x32_bf16 v[20:23], v[36:39], v[56:59], v[20:23]
    v_mfma_f32_16x16x32_bf16 v[24:27], v[36:39], v[72:75], v[24:27]
    v_mfma_f32_16x16x32_bf16 v[20:23], v[40:43], v[60:63], v[20:23]
    v_mfma_f32_16x16x32_bf16 v[24:27], v[40:43], v[76:79], v[24:27]
    s_nop 7
    ds_write2_b32 v10, v20, v24 offset0:0 offset1:4
    ds_write2_b32 v10, v21, v25 offset0:128 offset1:132
    s_waitcnt lgkmcnt(0)
    s_mov_b64 s[58:59], exec
    s_mov_b64 exec, 1
    v_mov_b32 v28, 134188
    v_mov_b32 v29, 1
    ds_add_rtn_u32 v30, v28, v29
    s_waitcnt lgkmcnt(0)
    v_readfirstlane_b32 s56, v30
    s_mov_b64 exec, s[58:59]
    s_cmp_eq_u32 s56, 7
    s_cbranch_scc0 L_VPOST
    s_mov_b64 exec, 1
    buffer_store_dword v11, off, s[44:47], s60 sc1
    s_mov_b64 exec, -1
    v_add_u32 v28, 98304, v8
    ds_read_b128 v[48:51], v28 offset:0
    ds_read_b128 v[52:55], v28 offset:1024
    ds_read_b128 v[56:59], v28 offset:2048
    ds_read_b128 v[60:63], v28 offset:3072
    ds_read_b128 v[64:67], v28 offset:4096
    ds_read_b128 v[68:71], v28 offset:5120
    ds_read_b128 v[72:75], v28 offset:6144
    ds_read_b128 v[76:79], v28 offset:7168
    v_lshrrev_b32 v29, 5, v1
    v_lshlrev_b32 v29, 2, v29
    v_add_u32 v30, 135160, v29
    v_lshlrev_b32 v31, 3, v29
    v_add_u32 v31, 134528, v31
    ds_read_b32 v44, v30
    ds_read_b128 v[80:83], v31
    ds_read_b128 v[84:87], v31 offset:16
    s_lshr_b32 s15, s2, 4
    s_and_b32 s15, s15, 1
    s_lshl_b32 s14, s4, 5
    s_lshl_b32 s15, s15, 4
    s_or_b32 s14, s14, s15
    s_or_b32 s14, s14, s5
    s_lshl_b32 s14, s14, 12
    s_add_u32 s14, s14, 1048576
    v_lshlrev_b32 v28, 4, v1
    v_mov_b32 v37, s43
    v_mov_b32 v39, s43
    v_mov_b32 v41, s43
    v_mov_b32 v43, s43
    v_mov_b32 v45, s43
    v_mov_b32 v47, s43
    s_mov_b32 s15, 0x3e0293ee
    v_lshlrev_b32 v29, 2, v29
    s_mov_b32 s58, 1
    s_mov_b32 s59, 1
    s_waitcnt lgkmcnt(0)
    v_add_f32 v48, v48, v52
    v_add_f32 v56, v56, v60
    v_add_f32 v64, v64, v68
    v_add_f32 v72, v72, v76
    v_add_f32 v48, v48, v56
    v_add_f32 v64, v64, v72
    v_add_f32 v36, v48, v64
    v_add_f32 v49, v49, v53
    v_add_f32 v57, v57, v61
    v_add_f32 v65, v65, v69
    v_add_f32 v73, v73, v77
    v_add_f32 v49, v49, v57
    v_add_f32 v65, v65, v73
    v_add_f32 v38, v49, v65
    buffer_store_dwordx4 v[36:39], v28, s[44:47], s14 offen sc1
    v_add_f32 v50, v50, v54
    v_add_f32 v58, v58, v62
    v_add_f32 v66, v66, v70
    v_add_f32 v74, v74, v78
    v_add_f32 v50, v50, v58
    v_add_f32 v66, v66, v74
    v_add_f32 v40, v50, v66
    v_add_f32 v51, v51, v55
    v_add_f32 v59, v59, v63
    v_add_f32 v67, v67, v71
    v_add_f32 v75, v75, v79
    v_add_f32 v51, v51, v59
    v_add_f32 v67, v67, v75
    v_add_f32 v42, v51, v67
    buffer_store_dwordx4 v[40:43], v28, s[44:47], s14 offen offset:1024 sc1
    v_add_f32 v80, v80, v81
    v_add_f32 v82, v82, v83
    v_add_f32 v84, v84, v85
    v_add_f32 v86, v86, v87
    v_mul_f32 v44, s15, v44
    v_add_f32 v80, v80, v82
    v_add_f32 v84, v84, v86
    v_add_f32 v46, v80, v84
    s_mov_b64 exec, s[58:59]
    buffer_store_dwordx4 v[44:47], v29, s[44:47], s14 offen offset:2048 sc1
    s_mov_b64 exec, -1
    s_branch L_VPOST
L_KWAVE:
    s_mov_b32 s48, s18
    s_mov_b32 s49, s19
    s_mov_b32 s50, 0x8000000
    s_mov_b32 s51, 0x00020000
    s_setprio 2
    s_barrier
    s_cmp_ge_u32 s10, 6
    s_cbranch_scc1 L_KLOAD
    s_cmp_ge_u32 s11, 208
    s_cbranch_scc1 L_KLOAD
    v_mov_b32 v11, 134204
    s_mov_b32 s57, 0
L_lw_5:
    ds_read_b32 v10, v11
    s_waitcnt lgkmcnt(0)
    v_readfirstlane_b32 s56, v10
    s_add_u32 s57, s57, 1
    s_cmp_ge_u32 s56, 1
    s_cbranch_scc1 L_lwd_6
    s_sleep 1
    s_cmp_lt_u32 s57, 0x40000
    s_cbranch_scc1 L_lw_5
L_lwd_6:
L_KLOAD:
    buffer_load_dwordx4 v[48:51], v9, s[48:51], s6 offen offset:0 nt
    buffer_load_dwordx4 v[52:55], v9, s[48:51], s6 offen offset:256 nt
    buffer_load_dwordx4 v[56:59], v9, s[48:51], s6 offen offset:512 nt
    buffer_load_dwordx4 v[60:63], v9, s[48:51], s6 offen offset:768 nt
    buffer_load_dwordx4 v[64:67], v9, s[48:51], s6 offen offset:1024 nt
    buffer_load_dwordx4 v[68:71], v9, s[48:51], s6 offen offset:1280 nt
    buffer_load_dwordx4 v[72:75], v9, s[48:51], s6 offen offset:1536 nt
    buffer_load_dwordx4 v[76:79], v9, s[48:51], s6 offen offset:1792 nt
    buffer_load_dwordx4 v[80:83], v9, s[48:51], s6 offen offset:2048 nt
    buffer_load_dwordx4 v[84:87], v9, s[48:51], s6 offen offset:2304 nt
    buffer_load_dwordx4 v[88:91], v9, s[48:51], s6 offen offset:2560 nt
    buffer_load_dwordx4 v[92:95], v9, s[48:51], s6 offen offset:2816 nt
    buffer_load_dwordx4 v[96:99], v9, s[48:51], s6 offen offset:3072 nt
    buffer_load_dwordx4 v[100:103], v9, s[48:51], s6 offen offset:3328 nt
    buffer_load_dwordx4 v[104:107], v9, s[48:51], s6 offen offset:3584 nt
    buffer_load_dwordx4 v[108:111], v9, s[48:51], s6 offen offset:3840 nt
    s_mov_b64 s[58:59], exec
    s_mov_b64 exec, 1
    v_mov_b32 v10, 134240
    v_mov_b32 v11, 1
    ds_add_u32 v10, v11
    s_mov_b64 exec, s[58:59]
    s_mov_b32 s61, 0
    s_cmp_ge_u32 s99, 162
    s_cbranch_scc1 L_NOHP
    s_cmp_ge_u32 s10, 6
    s_cbranch_scc1 L_NOHP
    s_mov_b32 s11, s99
    s_mul_i32 s12, s11, 7282
    s_lshr_b32 s12, s12, 16
    s_mul_i32 s13, s12, 9
    s_sub_u32 s13, s11, s13
    s_mul_i32 s14, s10, 53248
    s_lshl_b32 s15, s12, 10
    s_add_u32 s14, s14, s15
    s_add_u32 s14, s14, 81920
    s_add_u32 s15, s14, 18432
    buffer_load_dwordx4 v[120:123], v8, s[44:47], s14 offen sc1
    buffer_load_dwordx4 v[124:127], v8, s[44:47], s15 offen sc1
    s_mov_b32 s61, 2
L_NOHP:
    s_lshl_b32 s56, s10, 12
    s_add_u32 s56, s56, 98304
    v_xor_b32 v10, v6, v7
    v_lshlrev_b32 v10, 4, v10
    v_lshlrev_b32 v11, 8, v7
    v_add_u32 v12, v10, v11
    v_add_u32 v12, s56, v12
    v_xor_b32 v13, 64, v12
    v_xor_b32 v14, 0x80, v12
    v_xor_b32 v15, 0xc0, v12
    v_lshlrev_b32 v11, 8, v6
    v_add_u32 v16, v10, v11
    v_add_u32 v16, s56, v16
    v_xor_b32 v17, 64, v16
    v_xor_b32 v18, 0x80, v16
    v_xor_b32 v19, 0xc0, v16
    v_bfe_u32 v20, v6, 2, 1
    v_lshlrev_b32 v20, 8, v20
    v_lshlrev_b32 v21, 4, v7
    v_add_u32 v20, v20, v21
    v_add_u32 v20, 135168, v20
    s_waitcnt lgkmcnt(0)
    s_mul_i32 s43, s42, 0x9E3779B1
    s_add_u32 s43, s43, 0x7F4A7C15
    s_cmp_lt_u32 s10, 6
    s_cbranch_scc1 L_QWAIT
    s_sub_u32 s15, s10, 6
    s_mul_i32 s14, s4, 53248
    s_lshl_b32 s12, s5, 10
    s_add_u32 s14, s14, s12
    s_lshl_b32 s12, s15, 8
    s_add_u32 s14, s14, s12
    s_add_u32 s14, s14, 65536
    s_add_u32 s12, s40, s14
    s_addc_u32 s13, s41, 0
    s_mov_b32 s11, 0
L_qf_7:
    s_load_dwordx16 s[16:31], s[12:13], 0 glc
    s_load_dwordx16 s[56:71], s[12:13], 64 glc
    s_load_dwordx16 s[72:87], s[12:13], 128 glc
    s_load_dwordx8 s[32:39], s[12:13], 192 glc
    s_load_dwordx8 s[88:95], s[12:13], 224 glc
    s_add_u32 s11, s11, 1
    s_cmp_ge_u32 s11, 0x8000
    s_cbranch_scc1 L_qf_7_go
    s_waitcnt lgkmcnt(0)
    s_xor_b32 s14, s31, s43
    s_xor_b32 s100, s71, s43
    s_or_b32 s14, s14, s100
    s_xor_b32 s100, s87, s43
    s_or_b32 s14, s14, s100
    s_xor_b32 s100, s39, s43
    s_or_b32 s14, s14, s100
    s_xor_b32 s100, s95, s43
    s_or_b32 s14, s14, s100
    s_cbranch_scc1 L_qf_7
    v_writelane_b32 v24, s16, 0
    v_writelane_b32 v24, s17, 1
    v_writelane_b32 v24, s18, 2
    v_writelane_b32 v24, s19, 3
    v_writelane_b32 v24, s20, 4
    v_writelane_b32 v24, s21, 5
    v_writelane_b32 v24, s22, 6
    v_writelane_b32 v24, s23, 7
    v_writelane_b32 v24, s24, 8
    v_writelane_b32 v24, s25, 9
    v_writelane_b32 v24, s26, 10
    v_writelane_b32 v24, s27, 11
    v_writelane_b32 v24, s28, 12
    v_writelane_b32 v24, s29, 13
    v_writelane_b32 v24, s30, 14
    v_writelane_b32 v24, s31, 15
    v_writelane_b32 v24, s56, 16
    v_writelane_b32 v24, s57, 17
    v_writelane_b32 v24, s58, 18
    v_writelane_b32 v24, s59, 19
    v_writelane_b32 v24, s60, 20
    v_writelane_b32 v24, s61, 21
    v_writelane_b32 v24, s62, 22
    v_writelane_b32 v24, s63, 23
    v_writelane_b32 v24, s64, 24
    v_writelane_b32 v24, s65, 25
    v_writelane_b32 v24, s66, 26
    v_writelane_b32 v24, s67, 27
    v_writelane_b32 v24, s68, 28
    v_writelane_b32 v24, s69, 29
    v_writelane_b32 v24, s70, 30
    v_writelane_b32 v24, s71, 31
    v_writelane_b32 v24, s72, 32
    v_writelane_b32 v24, s73, 33
    v_writelane_b32 v24, s74, 34
    v_writelane_b32 v24, s75, 35
    v_writelane_b32 v24, s76, 36
    v_writelane_b32 v24, s77, 37
    v_writelane_b32 v24, s78, 38
    v_writelane_b32 v24, s79, 39
    v_writelane_b32 v24, s80, 40
    v_writelane_b32 v24, s81, 41
    v_writelane_b32 v24, s82, 42
    v_writelane_b32 v24, s83, 43
    v_writelane_b32 v24, s84, 44
    v_writelane_b32 v24, s85, 45
    v_writelane_b32 v24, s86, 46
    v_writelane_b32 v24, s87, 47
    v_writelane_b32 v24, s32, 48
    v_writelane_b32 v24, s33, 49
    v_writelane_b32 v24, s34, 50
    v_writelane_b32 v24, s35, 51
    v_writelane_b32 v24, s36, 52
    v_writelane_b32 v24, s37, 53
    v_writelane_b32 v24, s38, 54
    v_writelane_b32 v24, s39, 55
    v_writelane_b32 v24, s88, 56
    v_writelane_b32 v24, s89, 57
    v_writelane_b32 v24, s90, 58
    v_writelane_b32 v24, s91, 59
    v_writelane_b32 v24, s92, 60
    v_writelane_b32 v24, s93, 61
    v_writelane_b32 v24, s94, 62
    v_writelane_b32 v24, s95, 63
    s_mov_b32 s100, 0xaaaaaaaa
    s_mov_b32 s101, 0xaaaaaaaa
    s_nop 0
    v_cmp_ne_u32 vcc, s43, v24
    s_and_b64 vcc, vcc, s[100:101]
    s_cbranch_vccnz L_qf_7
L_qf_7_go:
    s_waitcnt lgkmcnt(0)
    v_lshrrev_b32 v25, 1, v1
    v_lshlrev_b32 v25, 2, v25
    s_lshl_b32 s14, s15, 7
    s_add_u32 s14, s14, 135168
    v_add_u32 v25, s14, v25
    s_mov_b32 s100, 0x55555555
    s_mov_b32 s101, 0x55555555
    s_mov_b64 exec, s[100:101]
    ds_write_b32 v25, v24
    s_mov_b64 exec, -1
    s_load_dwordx16 s[16:31], s[0:1], 0
    s_load_dwordx8 s[32:39], s[0:1], 64
    s_waitcnt lgkmcnt(0)
    s_mov_b64 s[58:59], exec
    s_mov_b64 exec, 1
    v_mov_b32 v25, 134180
    v_mov_b32 v26, 1
    ds_add_u32 v25, v26
    s_mov_b64 exec, s[58:59]
    s_mov_b32 s61, 0
    s_cmp_ge_u32 s99, 162
    s_cbranch_scc1 L_QWAIT
    s_mov_b32 s11, s99
    s_mul_i32 s12, s11, 7282
    s_lshr_b32 s12, s12, 16
    s_mul_i32 s13, s12, 9
    s_sub_u32 s13, s11, s13
    s_mul_i32 s14, s10, 53248
    s_lshl_b32 s15, s12, 10
    s_add_u32 s14, s14, s15
    s_add_u32 s14, s14, 81920
    s_add_u32 s15, s14, 18432
    buffer_load_dwordx4 v[120:123], v8, s[44:47], s14 offen sc1
    buffer_load_dwordx4 v[124:127], v8, s[44:47], s15 offen sc1
    s_mov_b32 s61, 2
L_QWAIT:
    v_mov_b32 v23, 134180
    s_mov_b32 s57, 0
L_lw_8:
    ds_read_b32 v22, v23
    s_waitcnt lgkmcnt(0)
    v_readfirstlane_b32 s56, v22
    s_add_u32 s57, s57, 1
    s_cmp_ge_u32 s56, 4
    s_cbranch_scc1 L_lwd_9
    s_sleep 1
    s_cmp_lt_u32 s57, 0x40000
    s_cbranch_scc1 L_lw_8
L_lwd_9:
    ds_read_b128 v[32:35], v20 offset:0
    ds_read_b128 v[36:39], v20 offset:64
    ds_read_b128 v[40:43], v20 offset:128
    ds_read_b128 v[44:47], v20 offset:192
    s_cmp_eq_u32 s61, 0
    s_cbranch_scc1 L_KW0
    s_waitcnt vmcnt(2)
    s_branch L_KW1
L_KW0:
    s_waitcnt vmcnt(0)
L_KW1:
    ds_write_b128 v12, v[48:51] offset:0
    ds_write_b128 v13, v[56:59] offset:1024
    ds_write_b128 v14, v[64:67] offset:2048
    ds_write_b128 v15, v[72:75] offset:3072
    ds_read_b128 v[48:51], v16
    ds_read_b128 v[56:59], v17
    ds_read_b128 v[64:67], v18
    ds_read_b128 v[72:75], v19
    s_waitcnt lgkmcnt(6)
    ds_write_b128 v12, v[52:55] offset:0
    ds_write_b128 v13, v[60:63] offset:1024
    ds_write_b128 v14, v[68:71] offset:2048
    ds_write_b128 v15, v[76:79] offset:3072
    ds_read_b128 v[52:55], v16
    ds_read_b128 v[60:63], v17
    ds_read_b128 v[68:71], v18
    ds_read_b128 v[76:79], v19
    s_waitcnt lgkmcnt(8)
    v_mfma_f32_16x16x32_bf16 v[112:115], v[32:35], v[48:51], 0
    v_mfma_f32_16x16x32_bf16 v[112:115], v[36:39], v[56:59], v[112:115]
    v_mfma_f32_16x16x32_bf16 v[112:115], v[40:43], v[64:67], v[112:115]
    v_mfma_f32_16x16x32_bf16 v[112:115], v[44:47], v[72:75], v[112:115]
    ds_write_b128 v12, v[80:83] offset:0
    ds_write_b128 v13, v[88:91] offset:1024
    ds_write_b128 v14, v[96:99] offset:2048
    ds_write_b128 v15, v[104:107] offset:3072
    ds_read_b128 v[80:83], v16
    ds_read_b128 v[88:91], v17
    ds_read_b128 v[96:99], v18
    ds_read_b128 v[104:107], v19
    s_waitcnt lgkmcnt(8)
    v_mfma_f32_16x16x32_bf16 v[116:119], v[32:35], v[52:55], 0
    v_mfma_f32_16x16x32_bf16 v[116:119], v[36:39], v[60:63], v[116:119]
    v_mfma_f32_16x16x32_bf16 v[116:119], v[40:43], v[68:71], v[116:119]
    v_mfma_f32_16x16x32_bf16 v[116:119], v[44:47], v[76:79], v[116:119]
    ds_write_b128 v12, v[84:87] offset:0
    ds_write_b128 v13, v[92:95] offset:1024
    ds_write_b128 v14, v[100:103] offset:2048
    ds_write_b128 v15, v[108:111] offset:3072
    ds_read_b128 v[84:87], v16
    ds_read_b128 v[92:95], v17
    ds_read_b128 v[100:103], v18
    ds_read_b128 v[108:111], v19
    s_waitcnt lgkmcnt(8)
    v_mfma_f32_16x16x32_bf16 v[24:27], v[32:35], v[80:83], 0
    v_mfma_f32_16x16x32_bf16 v[24:27], v[36:39], v[88:91], v[24:27]
    v_mfma_f32_16x16x32_bf16 v[24:27], v[40:43], v[96:99], v[24:27]
    v_mfma_f32_16x16x32_bf16 v[24:27], v[44:47], v[104:107], v[24:27]
    s_waitcnt lgkmcnt(0)
    v_mfma_f32_16x16x32_bf16 v[28:31], v[32:35], v[84:87], 0
    v_mfma_f32_16x16x32_bf16 v[28:31], v[36:39], v[92:95], v[28:31]
    v_mfma_f32_16x16x32_bf16 v[28:31], v[40:43], v[100:103], v[28:31]
    v_mfma_f32_16x16x32_bf16 v[28:31], v[44:47], v[108:111], v[28:31]
    v_and_b32 v22, 1, v7
    v_lshlrev_b32 v22, 2, v22
    v_lshlrev_b32 v23, 3, v22
    s_lshl_b32 s14, s10, 2
    s_add_u32 s14, s14, 134528
    v_add_u32 v23, s14, v23
    v_add_u32 v22, 135160, v22
    s_mov_b32 s58, 0x00010001
    s_mov_b32 s59, 0
    v_max_f32 v21, v112, v116
    s_nop 3
    v_max3_f32 v21, v21, v24, v28
    s_nop 1
    v_max_f32_dpp v21, v21, v21 quad_perm:[1,0,3,2] row_mask:0xf bank_mask:0xf
    s_nop 1
    v_max_f32_dpp v21, v21, v21 quad_perm:[2,3,0,1] row_mask:0xf bank_mask:0xf
    s_nop 1
    v_max_f32_dpp v21, v21, v21 row_half_mirror row_mask:0xf bank_mask:0xf
    s_nop 1
    v_max_f32_dpp v21, v21, v21 row_mirror row_mask:0xf bank_mask:0xf
    s_mov_b64 exec, s[58:59]
    ds_max_f32 v22, v21
    s_mov_b64 exec, -1
    s_waitcnt lgkmcnt(0)
    s_mov_b64 s[58:59], exec
    s_mov_b64 exec, 1
    v_mov_b32 v26, 134184
    v_mov_b32 v27, 1
    ds_add_u32 v26, v27
    s_mov_b64 exec, s[58:59]
    v_and_b32 v30, 3, v6
    v_lshlrev_b32 v30, 2, v30
    v_lshrrev_b32 v31, 2, v6
    v_add_u32 v30, v30, v31
    v_lshlrev_b32 v30, 2, v30
    v_lshlrev_b32 v31, 7, v7
    v_add_u32 v30, v30, v31
    s_lshl_b32 s14, s10, 8
    s_add_u32 s14, s14, 135680
    v_add_u32 v30, s14, v30
    s_lshl_b32 s15, s10, 2
    s_add_u32 s15, s15, 134208
    s_mov_b32 s14, 0x3e0293ee
    v_mov_b32 v27, 134184
    s_mov_b32 s57, 0
L_lw_10:
    ds_read_b32 v26, v27
    s_waitcnt lgkmcnt(0)
    v_readfirstlane_b32 s56, v26
    s_add_u32 s57, s57, 1
    s_cmp_ge_u32 s56, 8
    s_cbranch_scc1 L_lwd_11
    s_sleep 0
    s_cmp_lt_u32 s57, 0x40000
    s_cbranch_scc1 L_lw_10
L_lwd_11:
    ds_read_b32 v21, v22
    s_waitcnt lgkmcnt(0)
    v_mul_f32 v21, s14, v21
    v_fma_f32 v112, v112, s14, -v21
    v_fma_f32 v116, v116, s14, -v21
    v_fma_f32 v24, v24, s14, -v21
    v_fma_f32 v28, v28, s14, -v21
    v_exp_f32 v112, v112
    v_exp_f32 v116, v116
    v_exp_f32 v24, v24
    v_exp_f32 v28, v28
    s_nop 0
    v_add_f32 v26, v112, v116
    v_add_f32 v27, v24, v28
    v_cvt_pk_bf16_f32 v25, v112, v116
    v_cvt_pk_bf16_f32 v29, v24, v28
    v_add_f32 v26, v26, v27
    s_mov_b32 s58, -1
    s_mov_b32 s59, 0
    s_mov_b64 exec, s[58:59]
    ds_write_b32 v30, v25
    ds_write_b32 v30, v29 offset:64
    s_mov_b64 exec, -1
    s_nop 1
    v_add_f32_dpp v26, v26, v26 quad_perm:[1,0,3,2] row_mask:0xf bank_mask:0xf
    s_nop 1
    v_add_f32_dpp v26, v26, v26 quad_perm:[2,3,0,1] row_mask:0xf bank_mask:0xf
    s_nop 1
    v_add_f32_dpp v26, v26, v26 row_half_mirror row_mask:0xf bank_mask:0xf
    s_nop 1
    v_add_f32_dpp v26, v26, v26 row_mirror row_mask:0xf bank_mask:0xf
    s_mov_b32 s58, 0x00010001
    s_mov_b32 s59, 0
    s_mov_b64 exec, s[58:59]
    ds_write_b32 v23, v26
    s_mov_b64 exec, -1
    v_mov_b32 v30, s15
    v_mov_b32 v31, 1
    s_waitcnt lgkmcnt(0)
    s_mov_b64 exec, 1
    ds_write_b32 v30, v31
    s_mov_b64 exec, -1
    s_branch L_KPOST
L_KPOST:
    s_setprio 3
    s_cmp_lt_u32 s98, 48
    s_cbranch_scc1 L_KPOST_LIGHT
    s_cmp_ge_u32 s99, 162
    s_cbranch_scc1 L_HDONE
    s_mov_b32 s11, s99
    s_mul_i32 s12, s11, 7282
    s_lshr_b32 s12, s12, 16
    s_mul_i32 s13, s12, 9
    s_sub_u32 s13, s11, s13
    s_mul_i32 s14, s10, 53248
    s_lshl_b32 s15, s12, 10
    s_add_u32 s14, s14, s15
    s_add_u32 s14, s14, 81920
    s_add_u32 s15, s14, 18432
    s_mov_b32 s57, 0
    s_branch L_HCHK
L_HPOLL:
    s_sleep 8
    buffer_load_dwordx4 v[120:123], v8, s[44:47], s14 offen sc1
    buffer_load_dwordx4 v[124:127], v8, s[44:47], s15 offen sc1
L_HCHK:
    s_add_u32 s57, s57, 1
    s_waitcnt vmcnt(0)
    v_min3_u32 v32, v121, v123, v125
    v_max3_u32 v33, v121, v123, v125
    v_min_u32 v32, v32, v127
    v_max_u32 v33, v33, v127
    v_cmp_ne_u32 vcc, s43, v32
    v_cmp_ne_u32 s[58:59], s43, v33
    s_or_b64 vcc, vcc, s[58:59]
    s_cbranch_vccz L_HGOT
    s_cmp_lt_u32 s57, 0x10000
    s_cbranch_scc1 L_HPOLL
L_HGOT:
    s_cmp_eq_u32 s10, 7
    s_cbranch_scc1 L_HG2
L_HG2:
    v_lshlrev_b32 v32, 16, v120
    v_and_b32 v33, 0xffff0000, v120
    v_lshlrev_b32 v34, 16, v122
    v_and_b32 v35, 0xffff0000, v122
    v_lshlrev_b32 v36, 16, v124
    v_and_b32 v37, 0xffff0000, v124
    v_lshlrev_b32 v38, 16, v126
    v_and_b32 v39, 0xffff0000, v126
    s_mov_b32 s14, 0xbfb8aa3b
    v_mul_f32 v40, s14, v32
    v_mul_f32 v41, s14, v33
    v_mul_f32 v42, s14, v34
    v_mul_f32 v43, s14, v35
    v_exp_f32 v40, v40
    v_exp_f32 v41, v41
    v_exp_f32 v42, v42
    v_exp_f32 v43, v43
    s_nop 0
    v_add_f32 v40, 1.0, v40
    v_add_f32 v41, 1.0, v41
    v_add_f32 v42, 1.0, v42
    v_add_f32 v43, 1.0, v43
    v_rcp_f32 v40, v40
    v_rcp_f32 v41, v41
    v_rcp_f32 v42, v42
    v_rcp_f32 v43, v43
    s_nop 0
    v_mul_f32 v40, v32, v40
    v_mul_f32 v41, v33, v41
    v_mul_f32 v42, v34, v42
    v_mul_f32 v43, v35, v43
    v_cvt_pk_bf16_f32 v44, v40, v41
    v_cvt_pk_bf16_f32 v45, v42, v43
    v_lshlrev_b32 v40, 16, v44
    v_and_b32 v41, 0xffff0000, v44
    v_lshlrev_b32 v42, 16, v45
    v_and_b32 v43, 0xffff0000, v45
    v_mul_f32 v40, v40, v36
    v_mul_f32 v41, v41, v37
    v_mul_f32 v42, v42, v38
    v_mul_f32 v43, v43, v39
    v_cvt_pk_bf16_f32 v44, v40, v41
    v_cvt_pk_bf16_f32 v45, v42, v43
    s_mul_i32 s14, s10, 528
    s_add_u32 s14, s14, 137728
    v_lshlrev_b32 v46, 3, v1
    v_add_u32 v46, s14, v46
    ds_write_b64 v46, v[44:45]
    v_mov_b32 v33, 134200
    s_mov_b32 s57, 0
L_lw_12:
    ds_read_b32 v32, v33
    s_waitcnt lgkmcnt(0)
    v_readfirstlane_b32 s56, v32
    s_add_u32 s57, s57, 1
    s_cmp_ge_u32 s56, 8
    s_cbranch_scc1 L_lwd_13
    s_sleep 1
    s_cmp_lt_u32 s57, 0x40000
    s_cbranch_scc1 L_lw_12
L_lwd_13:
    v_mov_b32 v33, 134204
    s_mov_b32 s57, 0
L_lw_14:
    ds_read_b32 v32, v33
    s_waitcnt lgkmcnt(0)
    v_readfirstlane_b32 s56, v32
    s_add_u32 s57, s57, 1
    s_cmp_ge_u32 s56, 1
    s_cbranch_scc1 L_lwd_15
    s_sleep 1
    s_cmp_lt_u32 s57, 0x40000
    s_cbranch_scc1 L_lw_14
L_lwd_15:
    s_mov_b32 s52, s32
    s_mov_b32 s53, s33
    s_mov_b32 s54, 5308416
    s_mov_b32 s55, 0x00020000
    s_mov_b32 s56, 1152
    v_lshrrev_b32 v14, 3, v1
    v_mul_lo_u32 v12, v14, s56
    v_and_b32 v14, 1, v7
    v_lshlrev_b32 v14, 1, v14
    v_and_b32 v13, 7, v1
    v_xor_b32 v14, v14, v13
    v_lshlrev_b32 v13, 4, v14
    v_add_u32 v12, v12, v13
    v_xor_b32 v13, 64, v12
    s_lshl_b32 s14, s12, 8
    s_lshl_b32 s15, s10, 5
    s_add_u32 s14, s14, s15
    s_mul_i32 s14, s14, 1152
    s_lshl_b32 s15, s13, 7
    s_add_u32 s14, s14, s15
    s_lshl_b32 s15, s10, 12
    s_add_u32 m0, s15, 0
    s_nop 0
    buffer_load_dwordx4 v12, s[52:55], s14 offen nt lds
    s_add_u32 m0, s15, 1024
    s_add_u32 s14, s14, 9216
    buffer_load_dwordx4 v13, s[52:55], s14 offen nt lds
    s_add_u32 m0, s15, 2048
    s_add_u32 s14, s14, 9216
    buffer_load_dwordx4 v12, s[52:55], s14 offen nt lds
    s_add_u32 m0, s15, 3072
    s_add_u32 s14, s14, 9216
    buffer_load_dwordx4 v13, s[52:55], s14 offen nt lds
    s_waitcnt vmcnt(0) lgkmcnt(0)
    s_mov_b64 s[58:59], exec
    s_mov_b64 exec, 1
    v_mov_b32 v32, 134192
    v_mov_b32 v33, 1
    ds_add_u32 v32, v33
    s_mov_b64 exec, s[58:59]
    s_cmp_ge_u32 s10, 4
    s_cbranch_scc1 L_HDONE
    s_lshl_b32 s63, s13, 10
    s_lshl_b32 s14, s12, 2
    s_add_u32 s63, s63, s14
    s_add_u32 s63, s63, 36864
    s_add_u32 s12, s12, 16
    s_lshl_b32 s13, s13, 6
    s_mov_b32 s15, 0
    s_mov_b32 s14, s10
    v_lshrrev_b32 v28, 2, v6
    v_lshlrev_b32 v31, 3, v7
    v_add_u32 v31, v31, v28
    v_lshlrev_b32 v31, 7, v31
    v_lshrrev_b32 v28, 1, v28
    v_and_b32 v29, 1, v7
    v_lshlrev_b32 v29, 1, v29
    v_or_b32 v28, v28, v29
    v_lshlrev_b32 v28, 5, v28
    v_add_u32 v31, v31, v28
    v_and_b32 v28, 3, v6
    v_lshlrev_b32 v28, 3, v28
    v_add_u32 v28, v31, v28
    v_add_u32 v28, s15, v28
    v_xor_b32 v29, 32, v28
    v_xor_b32 v30, 64, v28
    v_xor_b32 v31, 0x60, v28
    s_lshl_b32 s56, s14, 5
    v_xor_b32 v28, s56, v28
    v_and_b32 v12, 7, v6
    v_mul_u32_u24 v13, 4608, v12
    v_mul_u32_u24 v12, 528, v12
    v_lshlrev_b32 v30, 4, v7
    v_add_u32 v12, v12, v30
    v_add_u32 v12, 137728, v12
    v_lshlrev_b32 v30, 4, v7
    v_add_u32 v13, v13, v30
    s_mul_i32 s62, s12, 36864
    s_lshl_b32 s57, s14, 4
    s_add_u32 s57, s57, s13
    s_lshl_b32 s57, s57, 3
    s_add_u32 s62, s62, s57
    s_add_u32 s62, s62, 2097152
    v_mov_b32 v31, 134192
    s_mov_b32 s57, 0
L_lw_16:
    ds_read_b32 v30, v31
    s_waitcnt lgkmcnt(0)
    v_readfirstlane_b32 s56, v30
    s_add_u32 s57, s57, 1
    s_cmp_ge_u32 s56, 8
    s_cbranch_scc1 L_lwd_17
    s_sleep 1
    s_cmp_lt_u32 s57, 0x40000
    s_cbranch_scc1 L_lw_16
L_lwd_17:
    ds_read_b64_tr_b16 v[48:49], v28 offset:0
    ds_read_b64_tr_b16 v[50:51], v28 offset:512
    ds_read_b64_tr_b16 v[52:53], v28 offset:4096
    ds_read_b64_tr_b16 v[54:55], v28 offset:4608
    ds_read_b64_tr_b16 v[56:57], v28 offset:8192
    ds_read_b64_tr_b16 v[58:59], v28 offset:8704
    ds_read_b64_tr_b16 v[60:61], v28 offset:12288
    ds_read_b64_tr_b16 v[62:63], v28 offset:12800
    s_waitcnt lgkmcnt(4)
    ds_read_b64_tr_b16 v[64:65], v28 offset:16384
    ds_read_b64_tr_b16 v[66:67], v28 offset:16896
    ds_read_b64_tr_b16 v[68:69], v28 offset:20480
    ds_read_b64_tr_b16 v[70:71], v28 offset:20992
    ds_read_b64_tr_b16 v[72:73], v28 offset:24576
    ds_read_b64_tr_b16 v[74:75], v28 offset:25088
    ds_read_b64_tr_b16 v[76:77], v28 offset:28672
    ds_read_b64_tr_b16 v[78:79], v28 offset:29184
    v_mov_b32 v113, s43
    v_mov_b32 v115, s43
    v_mov_b32 v117, s43
    v_mov_b32 v119, s43
    s_mov_b32 s64, 0x00ff00ff
    s_mov_b32 s65, 0x00ff00ff
    ds_read_b128 v[80:83], v12 offset:0
    ds_read_b128 v[84:87], v12 offset:64
    ds_read_b128 v[88:91], v12 offset:128
    ds_read_b128 v[92:95], v12 offset:192
    s_waitcnt vmcnt(0)
    ds_read_b128 v[96:99], v12 offset:256
    ds_read_b128 v[100:103], v12 offset:320
    ds_read_b128 v[104:107], v12 offset:384
    ds_read_b128 v[108:111], v12 offset:448
    s_waitcnt lgkmcnt(7)
    v_mfma_f32_16x16x32_bf16 v[20:23], v[48:51], v[80:83], 0
    s_waitcnt lgkmcnt(6)
    v_mfma_f32_16x16x32_bf16 v[24:27], v[52:55], v[84:87], 0
    s_waitcnt lgkmcnt(5)
    v_mfma_f32_16x16x32_bf16 v[20:23], v[56:59], v[88:91], v[20:23]
    s_waitcnt lgkmcnt(4)
    v_mfma_f32_16x16x32_bf16 v[24:27], v[60:63], v[92:95], v[24:27]
    s_waitcnt lgkmcnt(3)
    v_mfma_f32_16x16x32_bf16 v[20:23], v[64:67], v[96:99], v[20:23]
    s_waitcnt lgkmcnt(2)
    v_mfma_f32_16x16x32_bf16 v[24:27], v[68:71], v[100:103], v[24:27]
    s_waitcnt lgkmcnt(1)
    v_mfma_f32_16x16x32_bf16 v[20:23], v[72:75], v[104:107], v[20:23]
    s_waitcnt lgkmcnt(0)
    v_mfma_f32_16x16x32_bf16 v[24:27], v[76:79], v[108:111], v[24:27]
    s_mov_b64 exec, s[64:65]
    s_nop 6
    v_add_f32 v112, v20, v24
    v_add_f32 v114, v21, v25
    v_add_f32 v116, v22, v26
    v_add_f32 v118, v23, v27
    buffer_store_dwordx4 v[112:115], v13, s[44:47], s62 offen sc1
    buffer_store_dwordx4 v[116:119], v13, s[44:47], s62 offen offset:64 sc1
    s_mov_b64 exec, -1
    s_mov_b64 s[58:59], exec
    s_mov_b64 exec, 1
    v_mov_b32 v32, 134196
    v_mov_b32 v33, 1
    ds_add_rtn_u32 v34, v32, v33
    s_waitcnt lgkmcnt(0)
    v_readfirstlane_b32 s56, v34
    s_mov_b64 exec, s[58:59]
    s_cmp_eq_u32 s56, 3
    s_cbranch_scc0 L_HDONE
    v_mov_b32 v32, s43
    v_lshlrev_b32 v33, 7, v1
    s_mov_b64 exec, 0xff
    buffer_store_dword v32, v33, s[44:47], s63 offen sc1
    s_mov_b64 exec, -1
L_HDONE:
    s_cmp_eq_u32 s10, 7
    s_cbranch_scc0 L_FIN
    s_sub_u32 s11, s98, 48
    s_cmp_ge_u32 s11, 144
    s_cbranch_scc1 L_FIN
    s_setprio 0
    s_mul_i32 s12, s11, 3641
    s_lshr_b32 s12, s12, 16
    s_mul_i32 s13, s12, 18
    s_sub_u32 s13, s11, s13
    v_lshlrev_b32 v10, 1, v1
    s_mul_i32 s14, s12, 1152
    v_add_u32 v11, s14, v10
    global_load_ushort v24, v11, s[16:17] offset:0
    global_load_ushort v36, v10, s[34:35] offset:0
    global_load_ushort v25, v11, s[16:17] offset:128
    global_load_ushort v37, v10, s[34:35] offset:128
    global_load_ushort v26, v11, s[16:17] offset:256
    global_load_ushort v38, v10, s[34:35] offset:256
    global_load_ushort v27, v11, s[16:17] offset:384
    global_load_ushort v39, v10, s[34:35] offset:384
    global_load_ushort v28, v11, s[16:17] offset:512
    global_load_ushort v40, v10, s[34:35] offset:512
    global_load_ushort v29, v11, s[16:17] offset:640
    global_load_ushort v41, v10, s[34:35] offset:640
    global_load_ushort v30, v11, s[16:17] offset:768
    global_load_ushort v42, v10, s[34:35] offset:768
    global_load_ushort v31, v11, s[16:17] offset:896
    global_load_ushort v43, v10, s[34:35] offset:896
    global_load_ushort v32, v11, s[16:17] offset:1024
    global_load_ushort v44, v10, s[34:35] offset:1024
    s_lshr_b32 s14, s13, 1
    s_lshl_b32 s14, s14, 10
    s_lshl_b32 s15, s12, 7
    s_add_u32 s14, s14, s15
    s_add_u32 s14, s14, 36864
    s_add_u32 s90, s40, s14
    s_addc_u32 s91, s41, 0
    s_mul_i32 s14, s13, 43
    s_lshr_b32 s14, s14, 8
    s_lshl_b32 s14, s14, 10
    s_add_u32 s14, s14, s15
    s_add_u32 s14, s14, 32768
    s_add_u32 s92, s40, s14
    s_addc_u32 s93, s41, 0
    s_mov_b32 s70, s43
    s_mov_b32 s71, s43
    s_waitcnt vmcnt(0)
    v_lshlrev_b32 v24, 16, v24
    v_lshlrev_b32 v36, 16, v36
    v_lshlrev_b32 v25, 16, v25
    v_lshlrev_b32 v37, 16, v37
    v_lshlrev_b32 v26, 16, v26
    v_lshlrev_b32 v38, 16, v38
    v_lshlrev_b32 v27, 16, v27
    v_lshlrev_b32 v39, 16, v39
    v_lshlrev_b32 v28, 16, v28
    v_lshlrev_b32 v40, 16, v40
    v_lshlrev_b32 v29, 16, v29
    v_lshlrev_b32 v41, 16, v41
    v_lshlrev_b32 v30, 16, v30
    v_lshlrev_b32 v42, 16, v42
    v_lshlrev_b32 v31, 16, v31
    v_lshlrev_b32 v43, 16, v43
    v_lshlrev_b32 v32, 16, v32
    v_lshlrev_b32 v44, 16, v44
    v_mul_f32 v24, v24, v36
    v_mul_f32 v25, v25, v37
    v_mul_f32 v26, v26, v38
    v_mul_f32 v27, v27, v39
    v_mul_f32 v28, v28, v40
    v_mul_f32 v29, v29, v41
    v_mul_f32 v30, v30, v42
    v_mul_f32 v31, v31, v43
    v_mul_f32 v32, v32, v44
    v_cvt_pk_bf16_f32 v36, v24, v25
    v_cvt_pk_bf16_f32 v38, v26, v27
    v_cvt_pk_bf16_f32 v40, v28, v29
    v_cvt_pk_bf16_f32 v42, v30, v31
    v_cvt_pk_bf16_f32 v44, v32, v32
    v_mov_b32 v46, 0
    v_lshlrev_b32 v24, 16, v36
    v_and_b32 v25, 0xffff0000, v36
    v_add_f32 v46, v46, v24
    v_add_f32 v46, v46, v25
    v_lshlrev_b32 v24, 16, v38
    v_and_b32 v25, 0xffff0000, v38
    v_add_f32 v46, v46, v24
    v_add_f32 v46, v46, v25
    v_lshlrev_b32 v24, 16, v40
    v_and_b32 v25, 0xffff0000, v40
    v_add_f32 v46, v46, v24
    v_add_f32 v46, v46, v25
    v_lshlrev_b32 v24, 16, v42
    v_and_b32 v25, 0xffff0000, v42
    v_add_f32 v46, v46, v24
    v_add_f32 v46, v46, v25
    v_lshlrev_b32 v24, 16, v44
    v_add_f32 v46, v46, v24
    s_nop 1
    v_add_f32_dpp v46, v46, v46 quad_perm:[1,0,3,2] row_mask:0xf bank_mask:0xf
    s_nop 1
    v_add_f32_dpp v46, v46, v46 quad_perm:[2,3,0,1] row_mask:0xf bank_mask:0xf
    s_nop 1
    v_add_f32_dpp v46, v46, v46 row_half_mirror row_mask:0xf bank_mask:0xf
    s_nop 1
    v_add_f32_dpp v46, v46, v46 row_mirror row_mask:0xf bank_mask:0xf
    s_nop 1
    v_readlane_b32 s14, v46, 0
    v_readlane_b32 s15, v46, 16
    v_readlane_b32 s56, v46, 32
    v_readlane_b32 s57, v46, 48
    s_nop 1
    v_mov_b32 v46, s14
    v_add_f32 v46, s15, v46
    v_add_f32 v46, s56, v46
    v_add_f32 v46, s57, v46
    v_cvt_pk_bf16_f32 v46, v46, v46
    v_lshlrev_b32 v46, 16, v46
    v_mul_f32 v46, 0xbfb8aa3b, v46
    v_exp_f32 v46, v46
    s_nop 0
    v_add_f32 v46, 1.0, v46
    v_rcp_f32 v46, v46
    s_nop 0
    v_cvt_pk_bf16_f32 v46, v46, v46
    v_lshlrev_b32 v46, 16, v46
    v_sub_f32 v47, 1.0, v46
    v_cvt_pk_bf16_f32 v47, v47, v47
    v_lshlrev_b32 v47, 16, v47
    v_mul_u32_u24 v10, 36864, v7
    v_lshlrev_b32 v11, 4, v6
    v_add_u32 v10, v10, v11
    s_mul_i32 s14, s12, 4608
    s_lshl_b32 s15, s13, 8
    s_add_u32 s14, s14, s15
    s_add_u32 s14, s14, 2097152
    s_add_u32 s60, s14, 0
    s_add_u32 s61, s14, 147456
    s_add_u32 s62, s14, 294912
    s_add_u32 s63, s14, 442368
    s_add_u32 s64, s14, 589824
    s_add_u32 s65, s14, 737280
    s_add_u32 s66, s14, 884736
    s_add_u32 s67, s14, 1032192
    s_add_u32 s68, s14, 1179648
    v_mov_b32 v80, 0
    v_mov_b32 v81, s43
    v_mov_b32 v82, 0
    v_mov_b32 v83, s43
    s_mul_i32 s14, s12, 1152
    s_lshl_b32 s15, s13, 6
    s_add_u32 s14, s14, s15
    v_lshrrev_b32 v11, 3, v6
    v_lshlrev_b32 v11, 5, v11
    v_and_b32 v24, 3, v6
    v_lshlrev_b32 v24, 3, v24
    v_add_u32 v11, v11, v24
    v_bfe_u32 v24, v6, 2, 1
    v_lshlrev_b32 v24, 2, v24
    v_add_u32 v11, v11, v24
    v_add_u32 v11, s14, v11
    s_mov_b32 s52, s36
    s_mov_b32 s53, s37
    s_mov_b32 s54, 9216
    s_mov_b32 s55, 0x00020000
    s_setprio 3
    s_mov_b32 s57, 0
    s_mov_b32 s15, 0
L_RF:
    s_load_dwordx16 s[16:31], s[92:93], 0 glc
    s_cmp_lg_u32 s15, 0
    s_cbranch_scc1 L_RF_W
    s_load_dwordx16 s[72:87], s[90:91], 0 glc
    s_load_dwordx2 s[88:89], s[90:91], 64 glc
    s_waitcnt lgkmcnt(0)
    s_xor_b64 s[88:89], s[88:89], s[70:71]
    s_xor_b64 s[72:73], s[72:73], s[70:71]
    s_xor_b64 s[74:75], s[74:75], s[70:71]
    s_xor_b64 s[76:77], s[76:77], s[70:71]
    s_xor_b64 s[78:79], s[78:79], s[70:71]
    s_xor_b64 s[80:81], s[80:81], s[70:71]
    s_xor_b64 s[82:83], s[82:83], s[70:71]
    s_xor_b64 s[84:85], s[84:85], s[70:71]
    s_xor_b64 s[86:87], s[86:87], s[70:71]
    s_or_b64 s[72:73], s[72:73], s[74:75]
    s_or_b64 s[76:77], s[76:77], s[78:79]
    s_or_b64 s[80:81], s[80:81], s[82:83]
    s_or_b64 s[84:85], s[84:85], s[86:87]
    s_or_b64 s[72:73], s[72:73], s[76:77]
    s_or_b64 s[80:81], s[80:81], s[84:85]
    s_or_b64 s[72:73], s[72:73], s[80:81]
    s_or_b64 s[72:73], s[72:73], s[88:89]
    s_cbranch_scc1 L_RF_N
    buffer_load_dwordx4 v[64:67], v10, s[44:47], s64 offen sc1
    buffer_load_dwordx4 v[68:71], v10, s[44:47], s65 offen sc1
    buffer_load_dwordx4 v[72:75], v10, s[44:47], s66 offen sc1
    buffer_load_dwordx4 v[76:79], v10, s[44:47], s67 offen sc1
    s_mov_b32 s58, -1
    s_mov_b32 s59, 0
    s_mov_b64 exec, s[58:59]
    buffer_load_dwordx4 v[80:83], v10, s[44:47], s68 offen sc1
    s_mov_b64 exec, -1
    s_mov_b32 s15, 1
L_RF_W:
    s_waitcnt lgkmcnt(0)
    s_xor_b64 s[16:17], s[16:17], s[70:71]
    s_xor_b64 s[18:19], s[18:19], s[70:71]
    s_xor_b64 s[20:21], s[20:21], s[70:71]
    s_xor_b64 s[22:23], s[22:23], s[70:71]
    s_xor_b64 s[24:25], s[24:25], s[70:71]
    s_xor_b64 s[26:27], s[26:27], s[70:71]
    s_xor_b64 s[28:29], s[28:29], s[70:71]
    s_xor_b64 s[30:31], s[30:31], s[70:71]
    s_or_b64 s[16:17], s[16:17], s[18:19]
    s_or_b64 s[20:21], s[20:21], s[22:23]
    s_or_b64 s[24:25], s[24:25], s[26:27]
    s_or_b64 s[28:29], s[28:29], s[30:31]
    s_or_b64 s[16:17], s[16:17], s[20:21]
    s_or_b64 s[24:25], s[24:25], s[28:29]
    s_or_b64 s[16:17], s[16:17], s[24:25]
    s_cbranch_scc0 L_RF_D
L_RF_N:
    s_add_u32 s57, s57, 1
    s_cmp_lt_u32 s57, 0x10000
    s_cbranch_scc1 L_RF
L_RF_D:
    s_setprio 3
    s_mov_b32 s57, 0
    s_cmp_lg_u32 s15, 0
    s_cbranch_scc1 L_RP2
L_RPOLL:
    buffer_load_dwordx4 v[64:67], v10, s[44:47], s64 offen sc1
    buffer_load_dwordx4 v[68:71], v10, s[44:47], s65 offen sc1
    buffer_load_dwordx4 v[72:75], v10, s[44:47], s66 offen sc1
    buffer_load_dwordx4 v[76:79], v10, s[44:47], s67 offen sc1
    s_mov_b32 s58, -1
    s_mov_b32 s59, 0
    s_mov_b64 exec, s[58:59]
    buffer_load_dwordx4 v[80:83], v10, s[44:47], s68 offen sc1
    s_mov_b64 exec, -1
L_RP2:
    buffer_load_dwordx4 v[48:51], v10, s[44:47], s60 offen sc1
    buffer_load_dwordx4 v[52:55], v10, s[44:47], s61 offen sc1
    buffer_load_dwordx4 v[56:59], v10, s[44:47], s62 offen sc1
    buffer_load_dwordx4 v[60:63], v10, s[44:47], s63 offen sc1
    s_waitcnt vmcnt(4)
    v_min3_u32 v24, v65, v67, v69
    v_max3_u32 v25, v65, v67, v69
    v_min3_u32 v24, v24, v71, v73
    v_max3_u32 v25, v25, v71, v73
    v_min3_u32 v24, v24, v75, v77
    v_max3_u32 v25, v25, v75, v77
    v_min3_u32 v24, v24, v79, v81
    v_max3_u32 v25, v25, v79, v81
    v_min_u32 v24, v24, v83
    v_max_u32 v25, v25, v83
    v_add_f32 v28, v64, v68
    v_add_f32 v29, v66, v70
    v_cmp_ne_u32 vcc, s43, v24
    v_cmp_ne_u32 s[58:59], s43, v25
    v_add_f32 v32, v72, v76
    v_add_f32 v33, v74, v78
    s_or_b64 vcc, vcc, s[58:59]
    v_add_f32 v28, v28, v32
    v_add_f32 v29, v29, v33
    s_cbranch_vccz L_RHOK
    s_add_u32 s57, s57, 1
    s_waitcnt vmcnt(0)
    s_cmp_lt_u32 s57, 0x10000
    s_cbranch_scc1 L_RPOLL
L_RHOK:
    v_add_f32 v28, v28, v80
    v_add_f32 v29, v29, v82
    v_mov_b32 v30, v28
    v_mov_b32 v31, v29
    s_nop 1
    v_permlane32_swap_b32 v28, v30
    v_permlane32_swap_b32 v29, v31
    s_nop 1
    v_add_f32 v28, v28, v30
    v_add_f32 v29, v29, v31
    v_mov_b32 v30, v28
    v_mov_b32 v31, v29
    s_nop 1
    v_permlane16_swap_b32 v28, v30
    v_permlane16_swap_b32 v29, v31
    s_nop 1
    v_add_f32 v28, v28, v30
    v_add_f32 v29, v29, v31
    v_cvt_pk_bf16_f32 v31, v28, v29
    v_lshlrev_b32 v28, 16, v31
    v_and_b32 v29, 0xffff0000, v31
    v_mul_f32 v28, v47, v28
    v_mul_f32 v29, v47, v29
    v_cvt_pk_bf16_f32 v31, v28, v29
    v_lshlrev_b32 v28, 16, v31
    v_and_b32 v29, 0xffff0000, v31
L_RCHK:
    s_waitcnt vmcnt(0)
    v_min3_u32 v24, v49, v51, v53
    v_max3_u32 v25, v49, v51, v53
    v_min3_u32 v24, v24, v55, v57
    v_max3_u32 v25, v25, v55, v57
    v_min3_u32 v24, v24, v59, v61
    v_max3_u32 v25, v25, v59, v61
    v_min_u32 v24, v24, v63
    v_max_u32 v25, v25, v63
    v_add_f32 v26, v48, v52
    v_add_f32 v27, v50, v54
    v_cmp_ne_u32 vcc, s43, v24
    v_cmp_ne_u32 s[58:59], s43, v25
    v_add_f32 v30, v56, v60
    v_add_f32 v31, v58, v62
    s_or_b64 vcc, vcc, s[58:59]
    v_add_f32 v26, v26, v30
    v_add_f32 v27, v27, v31
    s_cbranch_vccz L_RGOT
    s_add_u32 s57, s57, 1
    s_cmp_ge_u32 s57, 0x10000
    s_cbranch_scc1 L_RGOT
    buffer_load_dwordx4 v[48:51], v10, s[44:47], s60 offen sc1
    buffer_load_dwordx4 v[52:55], v10, s[44:47], s61 offen sc1
    buffer_load_dwordx4 v[56:59], v10, s[44:47], s62 offen sc1
    buffer_load_dwordx4 v[60:63], v10, s[44:47], s63 offen sc1
    s_branch L_RCHK
L_RGOT:
    v_mov_b32 v30, v26
    v_mov_b32 v31, v27
    s_nop 1
    v_permlane32_swap_b32 v26, v30
    v_permlane32_swap_b32 v27, v31
    s_nop 1
    v_add_f32 v26, v26, v30
    v_add_f32 v27, v27, v31
    v_mov_b32 v30, v26
    v_mov_b32 v31, v27
    s_nop 1
    v_permlane16_swap_b32 v26, v30
    v_permlane16_swap_b32 v27, v31
    s_nop 1
    v_add_f32 v26, v26, v30
    v_add_f32 v27, v27, v31
    v_cvt_pk_bf16_f32 v30, v26, v27
    v_lshlrev_b32 v26, 16, v30
    v_and_b32 v27, 0xffff0000, v30
    v_mul_f32 v26, v46, v26
    v_mul_f32 v27, v46, v27
    v_cvt_pk_bf16_f32 v30, v26, v27
    v_lshlrev_b32 v26, 16, v30
    v_and_b32 v27, 0xffff0000, v30
    v_add_f32 v26, v26, v28
    v_add_f32 v27, v27, v29
    v_cvt_pk_bf16_f32 v30, v26, v27
    s_mov_b64 exec, 0xffff
    buffer_store_dword v30, v11, s[52:55], 0 offen
    s_cmp_eq_u32 s11, 0
    s_cbranch_scc0 L_RDONE
    s_mov_b64 exec, 1
    v_mov_b32 v11, s43
    buffer_store_dword v11, off, s[44:47], 0 sc1
L_RDONE:
    s_mov_b64 exec, -1
    s_branch L_FIN
L_KPOST_LIGHT:
    s_and_b32 s12, s98, 15
    s_lshr_b32 s13, s98, 4
    v_mov_b32 v33, 134200
    s_mov_b32 s57, 0
L_lw_18:
    ds_read_b32 v32, v33
    s_waitcnt lgkmcnt(0)
    v_readfirstlane_b32 s56, v32
    s_add_u32 s57, s57, 1
    s_cmp_ge_u32 s56, 8
    s_cbranch_scc1 L_lwd_19
    s_sleep 1
    s_cmp_lt_u32 s57, 0x40000
    s_cbranch_scc1 L_lw_18
L_lwd_19:
    s_mov_b32 s52, s24
    s_mov_b32 s53, s25
    s_mov_b32 s54, 4718592
    s_mov_b32 s55, 0x00020000
    s_mov_b32 s56, 1152
    v_lshrrev_b32 v14, 3, v1
    v_mul_lo_u32 v12, v14, s56
    v_and_b32 v14, 1, v7
    v_lshlrev_b32 v14, 1, v14
    v_and_b32 v13, 7, v1
    v_xor_b32 v14, v14, v13
    v_lshlrev_b32 v13, 4, v14
    v_add_u32 v12, v12, v13
    v_xor_b32 v13, 64, v12
    s_lshl_b32 s14, s12, 8
    s_lshl_b32 s15, s10, 5
    s_add_u32 s14, s14, s15
    s_mul_i32 s14, s14, 1152
    s_mul_i32 s15, s13, 384
    s_add_u32 s14, s14, s15
    s_lshl_b32 s15, s10, 12
    s_add_u32 m0, s15, 0
    s_add_u32 s56, s14, 0
    buffer_load_dwordx4 v12, s[52:55], s56 offen nt lds
    s_add_u32 m0, s15, 32768
    s_add_u32 s56, s14, 128
    buffer_load_dwordx4 v12, s[52:55], s56 offen nt lds
    s_add_u32 m0, s15, 65536
    s_add_u32 s56, s14, 256
    buffer_load_dwordx4 v12, s[52:55], s56 offen nt lds
    s_add_u32 s14, s14, 9216
    s_add_u32 m0, s15, 1024
    s_add_u32 s56, s14, 0
    buffer_load_dwordx4 v13, s[52:55], s56 offen nt lds
    s_add_u32 m0, s15, 33792
    s_add_u32 s56, s14, 128
    buffer_load_dwordx4 v13, s[52:55], s56 offen nt lds
    s_add_u32 m0, s15, 66560
    s_add_u32 s56, s14, 256
    buffer_load_dwordx4 v13, s[52:55], s56 offen nt lds
    s_add_u32 s14, s14, 9216
    s_add_u32 m0, s15, 2048
    s_add_u32 s56, s14, 0
    buffer_load_dwordx4 v12, s[52:55], s56 offen nt lds
    s_add_u32 m0, s15, 34816
    s_add_u32 s56, s14, 128
    buffer_load_dwordx4 v12, s[52:55], s56 offen nt lds
    s_add_u32 m0, s15, 67584
    s_add_u32 s56, s14, 256
    buffer_load_dwordx4 v12, s[52:55], s56 offen nt lds
    s_add_u32 s14, s14, 9216
    s_add_u32 m0, s15, 3072
    s_add_u32 s56, s14, 0
    buffer_load_dwordx4 v13, s[52:55], s56 offen nt lds
    s_add_u32 m0, s15, 35840
    s_add_u32 s56, s14, 128
    buffer_load_dwordx4 v13, s[52:55], s56 offen nt lds
    s_add_u32 m0, s15, 68608
    s_add_u32 s56, s14, 256
    buffer_load_dwordx4 v13, s[52:55], s56 offen nt lds
    s_add_u32 s14, s14, 9216
    s_waitcnt vmcnt(0)
    s_mov_b64 s[58:59], exec
    s_mov_b64 exec, 1
    v_mov_b32 v32, 134192
    v_mov_b32 v33, 1
    ds_add_u32 v32, v33
    s_mov_b64 exec, s[58:59]
L_VPOST_LIGHT:
    s_cmp_ge_u32 s3, 12
    s_cbranch_scc1 L_LPRE_D
    s_and_b32 s12, s98, 15
    s_lshr_b32 s13, s98, 4
    s_mul_i32 s13, s13, 192
    s_lshr_b32 s15, s3, 2
    s_lshl_b32 s14, s15, 6
    s_add_u32 s13, s13, s14
    s_lshl_b32 s15, s15, 15
    s_and_b32 s14, s3, 3
    v_lshrrev_b32 v28, 2, v6
    v_lshlrev_b32 v31, 3, v7
    v_add_u32 v31, v31, v28
    v_lshlrev_b32 v31, 7, v31
    v_lshrrev_b32 v28, 1, v28
    v_and_b32 v29, 1, v7
    v_lshlrev_b32 v29, 1, v29
    v_or_b32 v28, v28, v29
    v_lshlrev_b32 v28, 5, v28
    v_add_u32 v31, v31, v28
    v_and_b32 v28, 3, v6
    v_lshlrev_b32 v28, 3, v28
    v_add_u32 v28, v31, v28
    v_add_u32 v28, s15, v28
    v_xor_b32 v29, 32, v28
    v_xor_b32 v30, 64, v28
    v_xor_b32 v31, 0x60, v28
    s_lshl_b32 s56, s14, 5
    v_xor_b32 v28, s56, v28
    v_and_b32 v12, 7, v6
    v_mul_u32_u24 v13, 4608, v12
    v_mul_u32_u24 v12, 528, v12
    v_lshlrev_b32 v30, 4, v7
    v_add_u32 v12, v12, v30
    v_add_u32 v12, 137728, v12
    v_lshlrev_b32 v30, 4, v7
    v_add_u32 v13, v13, v30
    s_mul_i32 s62, s12, 36864
    s_lshl_b32 s57, s14, 4
    s_add_u32 s57, s57, s13
    s_lshl_b32 s57, s57, 3
    s_add_u32 s62, s62, s57
    s_add_u32 s62, s62, 2097152
    v_mov_b32 v31, 134192
    s_mov_b32 s57, 0
L_lw_20:
    ds_read_b32 v30, v31
    s_waitcnt lgkmcnt(0)
    v_readfirstlane_b32 s56, v30
    s_add_u32 s57, s57, 1
    s_cmp_ge_u32 s56, 8
    s_cbranch_scc1 L_lwd_21
    s_sleep 1
    s_cmp_lt_u32 s57, 0x40000
    s_cbranch_scc1 L_lw_20
L_lwd_21:
    ds_read_b64_tr_b16 v[48:49], v28 offset:0
    ds_read_b64_tr_b16 v[50:51], v28 offset:512
    ds_read_b64_tr_b16 v[52:53], v28 offset:4096
    ds_read_b64_tr_b16 v[54:55], v28 offset:4608
    ds_read_b64_tr_b16 v[56:57], v28 offset:8192
    ds_read_b64_tr_b16 v[58:59], v28 offset:8704
    ds_read_b64_tr_b16 v[60:61], v28 offset:12288
    ds_read_b64_tr_b16 v[62:63], v28 offset:12800
    s_waitcnt lgkmcnt(4)
    ds_read_b64_tr_b16 v[64:65], v28 offset:16384
    ds_read_b64_tr_b16 v[66:67], v28 offset:16896
    ds_read_b64_tr_b16 v[68:69], v28 offset:20480
    ds_read_b64_tr_b16 v[70:71], v28 offset:20992
    ds_read_b64_tr_b16 v[72:73], v28 offset:24576
    ds_read_b64_tr_b16 v[74:75], v28 offset:25088
    ds_read_b64_tr_b16 v[76:77], v28 offset:28672
    ds_read_b64_tr_b16 v[78:79], v28 offset:29184
    v_mov_b32 v113, s43
    v_mov_b32 v115, s43
    v_mov_b32 v117, s43
    v_mov_b32 v119, s43
    s_mov_b32 s64, 0x00ff00ff
    s_mov_b32 s65, 0x00ff00ff
L_LPRE_D:
    s_lshr_b32 s4, s3, 1
    s_and_b32 s5, s3, 1
    s_and_b32 s12, s98, 15
    s_lshl_b32 s14, s4, 5
    s_add_u32 s14, s14, s12
    s_lshl_b32 s14, s14, 12
    s_add_u32 s14, s14, 1048576
    s_lshl_b32 s15, s5, 9
    s_add_u32 s6, s14, s15
    s_add_u32 s7, s6, 0x10000
    s_lshl_b32 s15, s5, 4
    s_add_u32 s8, s14, s15
    s_add_u32 s8, s8, 2048
    s_add_u32 s9, s8, 0x10000
    s_lshl_b32 s60, s12, 10
    s_lshl_b32 s14, s4, 7
    s_add_u32 s60, s60, s14
    s_add_u32 s60, s60, 16384
    s_add_u32 s66, s40, s60
    s_addc_u32 s67, s41, 0
    v_lshlrev_b32 v5, 7, v1
    s_lshr_b32 s63, s98, 4
    s_lshl_b32 s63, s63, 10
    s_lshl_b32 s14, s12, 2
    s_add_u32 s63, s63, s14
    s_add_u32 s63, s63, 32768
    s_mul_i32 s14, s4, 528
    s_lshl_b32 s15, s5, 8
    s_add_u32 s14, s14, s15
    s_add_u32 s14, s14, 137728
    v_and_b32 v4, 31, v1
    v_lshrrev_b32 v3, 5, v1
    v_lshlrev_b32 v11, 3, v4
    v_lshlrev_b32 v10, 2, v3
    v_add_u32 v11, v11, v10
    v_lshlrev_b32 v4, 4, v4
    v_lshlrev_b32 v3, 10, v3
    v_add_u32 v4, v4, v3
    v_add_u32 v11, s14, v11
    v_mov_b32 v10, 0
    v_mov_b32 v9, s43
    s_mov_b32 s68, s43
    s_mov_b32 s69, s43
    s_mov_b32 s57, 0
L_OPRE:
    s_load_dwordx2 s[60:61], s[66:67], 0 glc
    s_add_u32 s57, s57, 1
    s_waitcnt lgkmcnt(0)
    s_cmp_eq_u64 s[60:61], s[68:69]
    s_cbranch_scc1 L_OPRE_D
    s_cmp_lt_u32 s57, 0x10000
    s_cbranch_scc1 L_OPRE
L_OPRE_D:
    s_mov_b32 s57, 0
    buffer_load_dwordx4 v[32:35], v10, s[44:47], s8 offen sc1
    buffer_load_dwordx4 v[36:39], v10, s[44:47], s9 offen sc1
    buffer_load_dwordx4 v[24:27], v4, s[44:47], s6 offen sc1
    buffer_load_dwordx4 v[28:31], v4, s[44:47], s7 offen sc1
L_OPOLL:
    s_waitcnt vmcnt(2)
    v_max_f32 v40, v32, v36
    v_sub_f32 v42, v32, v40
    v_sub_f32 v43, v36, v40
    v_exp_f32 v42, v42
    v_exp_f32 v43, v43
    v_min3_u32 v44, v33, v35, v37
    v_max3_u32 v45, v33, v35, v37
    v_mul_f32 v40, v42, v34
    v_fma_f32 v40, v43, v38, v40
    v_rcp_f32 v40, v40
    v_min_u32 v44, v44, v39
    v_max_u32 v45, v45, v39
    v_mul_f32 v42, v42, v40
    v_mul_f32 v43, v43, v40
    s_waitcnt vmcnt(0)
    v_min3_u32 v44, v44, v25, v27
    v_max3_u32 v45, v45, v25, v27
    v_min3_u32 v44, v44, v29, v31
    v_max3_u32 v45, v45, v29, v31
    v_mul_f32 v24, v24, v42
    v_mul_f32 v26, v26, v42
    v_cmp_ne_u32 vcc, s43, v44
    v_cmp_ne_u32 s[58:59], s43, v45
    v_fma_f32 v24, v28, v43, v24
    v_fma_f32 v26, v30, v43, v26
    s_or_b64 vcc, vcc, s[58:59]
    v_cvt_pk_bf16_f32 v24, v24, v26
    s_cbranch_vccz L_OGOT
    s_add_u32 s57, s57, 1
    s_cmp_ge_u32 s57, 0x10000
    s_cbranch_scc1 L_OGOT
    buffer_load_dwordx4 v[32:35], v10, s[44:47], s8 offen sc1
    buffer_load_dwordx4 v[36:39], v10, s[44:47], s9 offen sc1
    buffer_load_dwordx4 v[24:27], v4, s[44:47], s6 offen sc1
    buffer_load_dwordx4 v[28:31], v4, s[44:47], s7 offen sc1
    s_branch L_OPOLL
L_OGOT:
    ds_write_b32 v11, v24
    s_waitcnt lgkmcnt(0)
    s_barrier
L_LNOBAR:
    s_cmp_ge_u32 s3, 12
    s_cbranch_scc1 L_LFLAG
    ds_read_b128 v[80:83], v12 offset:0
    ds_read_b128 v[84:87], v12 offset:64
    ds_read_b128 v[88:91], v12 offset:128
    ds_read_b128 v[92:95], v12 offset:192
    s_waitcnt vmcnt(0)
    ds_read_b128 v[96:99], v12 offset:256
    ds_read_b128 v[100:103], v12 offset:320
    ds_read_b128 v[104:107], v12 offset:384
    ds_read_b128 v[108:111], v12 offset:448
    s_waitcnt lgkmcnt(7)
    v_mfma_f32_16x16x32_bf16 v[20:23], v[48:51], v[80:83], 0
    s_waitcnt lgkmcnt(6)
    v_mfma_f32_16x16x32_bf16 v[24:27], v[52:55], v[84:87], 0
    s_waitcnt lgkmcnt(5)
    v_mfma_f32_16x16x32_bf16 v[20:23], v[56:59], v[88:91], v[20:23]
    s_waitcnt lgkmcnt(4)
    v_mfma_f32_16x16x32_bf16 v[24:27], v[60:63], v[92:95], v[24:27]
    s_waitcnt lgkmcnt(3)
    v_mfma_f32_16x16x32_bf16 v[20:23], v[64:67], v[96:99], v[20:23]
    s_waitcnt lgkmcnt(2)
    v_mfma_f32_16x16x32_bf16 v[24:27], v[68:71], v[100:103], v[24:27]
    s_waitcnt lgkmcnt(1)
    v_mfma_f32_16x16x32_bf16 v[20:23], v[72:75], v[104:107], v[20:23]
    s_waitcnt lgkmcnt(0)
    v_mfma_f32_16x16x32_bf16 v[24:27], v[76:79], v[108:111], v[24:27]
    s_mov_b64 exec, s[64:65]
    s_nop 6
    v_add_f32 v112, v20, v24
    v_add_f32 v114, v21, v25
    v_add_f32 v116, v22, v26
    v_add_f32 v118, v23, v27
    buffer_store_dwordx4 v[112:115], v13, s[44:47], s62 offen sc1
    buffer_store_dwordx4 v[116:119], v13, s[44:47], s62 offen offset:64 sc1
    s_mov_b64 exec, -1
    s_branch L_FIN
L_LFLAG:
    s_cmp_eq_u32 s3, 12
    s_cbranch_scc0 L_FIN
    s_mov_b64 exec, 0xff
    buffer_store_dword v9, v5, s[44:47], s63 offen sc1
    s_mov_b64 exec, -1
    s_branch L_FIN
L_VPOST:
    s_cmp_lt_u32 s98, 48
    s_cbranch_scc1 L_VPOST_LIGHT
    s_branch L_FIN
L_FIN:
L_END:
    s_endpgm
.section .rodata,"a"
.p2align 6
.amdhsa_kernel gated_mix__sliding_block_cached__swiglu_ffn__decode_kernel
  .amdhsa_next_free_vgpr 128
  .amdhsa_next_free_sgpr 102
  .amdhsa_accum_offset 128
  .amdhsa_group_segment_fixed_size 0
  .amdhsa_kernarg_size 104
  .amdhsa_user_sgpr_count 2
  .amdhsa_user_sgpr_kernarg_segment_ptr 1
  .amdhsa_system_sgpr_workgroup_id_x 1
.end_amdhsa_kernel
```
